```python
import torch

def _softmax(x, axis=-1):
    return torch.softmax(x, dim=axis)
def _gelu(x):
    return torch.nn.functional.gelu(x, approximate="tanh")
def _silu(x):
    return torch.nn.functional.silu(x)
def _sigmoid(x):
    return torch.sigmoid(x)
def _layernorm(x, axis=-1, eps=1e-5):
    m = x.mean(dim=axis, keepdim=True)
    v = x.var(dim=axis, keepdim=True, unbiased=False)
    return (x - m) / torch.sqrt(v + eps)
def _scatter_add(tgt, idx, src, axis=0):
    return tgt.clone().index_add_(axis, idx, src)
def _segment_sum(src, seg, n):
    out = torch.zeros((n,) + src.shape[1:], dtype=src.dtype)
    return out.index_add_(0, seg, src)
def _pad(x, pw):
    flat = tuple(v for pair in reversed(pw) for v in pair)
    return torch.nn.functional.pad(x, flat)

kernel_name = 'sequential_preLN__mha_block__dense_activation_relu__prompt'

def setup_inputs():

    _w = (lambda a: (lambda t: t.to(torch.bfloat16) if t.is_floating_point() else t)(torch.as_tensor(a)))
    def _A_setup():
        B, S, D, H = 1, 2048, 512, 32
        return {
            "x": _w((lambda *s: torch.randn(*s, dtype=torch.bfloat16) * 0.05)(B, S, D)),
            "wqkv": _w((lambda *s: torch.randn(*s, dtype=torch.bfloat16) * 0.05)(D, 3 * D)),
            "wo": _w((lambda *s: torch.randn(*s, dtype=torch.bfloat16) * 0.05)(D, D)),
        }
    _A_in = _A_setup()

    def _B_setup():
        B, S, D, Dff = 1, 2048, 512, 1792
        return {
            "x": _w((lambda *s: torch.randn(*s, dtype=torch.bfloat16) * 0.05)(B, S, D)),
            "w1": _w((lambda *s: torch.randn(*s, dtype=torch.bfloat16) * 0.05)(D, Dff)),
            "w2": _w((lambda *s: torch.randn(*s, dtype=torch.bfloat16) * 0.05)(Dff, D)),
        }
    _B_in = _B_setup()

    return {
        "A_x": _A_in["x"],
        "A_wqkv": _A_in["wqkv"],
        "A_wo": _A_in["wo"],
        "B_x": _B_in["x"],
        "B_w1": _B_in["w1"],
        "B_w2": _B_in["w2"],
    }

def reference(A_x, A_wqkv, A_wo, B_x, B_w1, B_w2):
    def _A_ref(x, wqkv, wo):
        B, S, D = x.shape
        H = 32
        Dh = D // H
        qkv = (lambda x, *d: x.permute(*d))((x @ wqkv).reshape(B, S, 3, H, Dh), 2, 0, 3, 1, 4)
        q, k, v = qkv[0], qkv[1], qkv[2]
        scores = torch.einsum("bhqd,bhkd->bhqk", q, k) * (Dh ** -0.5)
        p = _softmax(scores, axis=-1)
        o = torch.einsum("bhqk,bhkd->bhqd", p, v)
        return (lambda x, *d: x.permute(*d))(o, 0, 2, 1, 3).reshape(B, S, D) @ wo

    def _B_ref(x, w1, w2):
        h = torch.einsum("bsd,df->bsf", x, w1)
        zero = torch.zeros_like(h)
        h = torch.maximum(h, zero)
        return torch.einsum("bsf,fd->bsd", h, w2)

    x = A_x
    h = x + _A_ref(_layernorm(x, axis=-1), A_wqkv, A_wo)
    h2 = h + _B_ref(_layernorm(h, axis=-1), B_w1, B_w2)
    return h2
```

```asm
; @launch kernel=qkv_kernel grid=(256,1,1) block=(512,1,1) lds=163840
; @launch kernel=block_kernel grid=(256,1,1) block=(512,1,1) lds=163840
.amdgcn_target "amdgcn-amd-amdhsa--gfx950"
.text
.globl qkv_kernel
.p2align 8
.type qkv_kernel,@function
qkv_kernel:
    s_cmp_ge_u32 s2, 256
    s_cbranch_scc1 qkv_kernel_end
    s_load_dwordx4 s[4:7], s[0:1], 0
    s_load_dwordx2 s[8:9], s[0:1], 64
    v_and_b32 v1, 63, v0
    v_and_b32 v2, 31, v0
    v_bfe_u32 v3, v0, 5, 1
    v_lshrrev_b32 v4, 6, v0
    s_and_b32 s30, s2, 7
    v_readfirstlane_b32 s24, v4
    s_lshr_b32 s31, s2, 3
    s_lshr_b32 s38, s24, 2
    s_and_b32 s24, s24, 3
    s_lshr_b32 s25, s30, 1
    s_lshl_b32 s25, s25, 3
    s_lshr_b32 s32, s31, 2
    s_add_u32 s25, s25, s32
    s_and_b32 s26, s30, 1
    s_lshl_b32 s26, s26, 2
    s_and_b32 s31, s31, 3
    s_add_u32 s26, s26, s31
    s_lshl_b32 s33, s31, 1
    s_add_u32 s33, s33, s32
    s_add_u32 s33, s31, s32
    s_and_b32 s33, s33, 1
    s_lshl_b32 s33, s33, 2
    s_lshr_b32 s36, s30, 1
    s_add_u32 s33, s33, s36
    s_lshr_b32 s34, s24, 1
    s_and_b32 s35, s24, 1
    v_and_b32 v4, 7, v1
    v_lshrrev_b32 v5, 4, v1
    v_xor_b32 v6, v4, v5
    v_lshlrev_b32 v6, 4, v6
    v_lshrrev_b32 v7, 3, v1
    v_lshl_add_u32 v12, v7, 10, v6
    v_xor_b32 v13, 64, v12
    v_add_u32 v13, 7168, v13
    v_and_b32 v5, 1, v5
    v_lshlrev_b32 v5, 2, v5
    v_xor_b32 v4, v4, v5
    v_lshlrev_b32 v4, 4, v4
    v_mul_u32_u24 v7, 3072, v7
    v_add_u32 v14, v4, v7
    v_add_u32 v15, 23552, v14
    s_lshl_b32 s27, s24, 14
    s_mul_i32 s28, s24, 49152
    s_lshl_b32 s30, s26, 7
    s_add_u32 s28, s28, s30
    s_lshl_b32 s29, s24, 11
    s_lshl_b32 s30, s25, 16
    s_cmp_eq_u32 s38, 0
    s_cbranch_scc1 qkv_kernel_compute
    s_waitcnt lgkmcnt(0)
    s_add_u32 s12, s4, s30
    s_addc_u32 s13, s5, 0
    s_mov_b32 s14, 65536
    s_mov_b32 s15, 0x20000
    s_mov_b32 s16, s6
    s_mov_b32 s17, s7
    s_mov_b32 s18, 1572864
    s_mov_b32 s19, 0x20000
    s_add_u32 s30, s33, 0
    s_and_b32 s30, s30, 7
    s_lshl_b32 s36, s30, 7
    s_add_u32 m0, s29, 0
    s_add_u32 s36, s36, s27
    buffer_load_dwordx4 v12, s[12:15], s36 offen lds
    buffer_load_dwordx4 v13, s[12:15], s36 offen offset:1024 lds
    s_mul_i32 s37, s30, 196608
    s_add_u32 s37, s37, s28
    s_add_u32 m0, s29, 8192
    s_nop 0
    buffer_load_dwordx4 v14, s[16:19], s37 offen lds
    buffer_load_dwordx4 v15, s[16:19], s37 offen offset:1024 lds
    s_add_u32 m0, s29, 16384
    s_add_u32 s37, s37, 1024
    buffer_load_dwordx4 v14, s[16:19], s37 offen lds
    buffer_load_dwordx4 v15, s[16:19], s37 offen offset:1024 lds
    s_add_u32 m0, s29, 24576
    s_add_u32 s37, s37, 1024
    buffer_load_dwordx4 v14, s[16:19], s37 offen lds
    buffer_load_dwordx4 v15, s[16:19], s37 offen offset:1024 lds
    s_add_u32 s30, s33, 1
    s_and_b32 s30, s30, 7
    s_lshl_b32 s36, s30, 7
    s_add_u32 m0, s29, 32768
    s_add_u32 s36, s36, s27
    buffer_load_dwordx4 v12, s[12:15], s36 offen lds
    buffer_load_dwordx4 v13, s[12:15], s36 offen offset:1024 lds
    s_mul_i32 s37, s30, 196608
    s_add_u32 s37, s37, s28
    s_add_u32 m0, s29, 40960
    s_nop 0
    buffer_load_dwordx4 v14, s[16:19], s37 offen lds
    buffer_load_dwordx4 v15, s[16:19], s37 offen offset:1024 lds
    s_add_u32 m0, s29, 49152
    s_add_u32 s37, s37, 1024
    buffer_load_dwordx4 v14, s[16:19], s37 offen lds
    buffer_load_dwordx4 v15, s[16:19], s37 offen offset:1024 lds
    s_add_u32 m0, s29, 57344
    s_add_u32 s37, s37, 1024
    buffer_load_dwordx4 v14, s[16:19], s37 offen lds
    buffer_load_dwordx4 v15, s[16:19], s37 offen offset:1024 lds
    s_waitcnt vmcnt(8)
    s_barrier
    s_add_u32 s30, s33, 2
    s_and_b32 s30, s30, 7
    s_lshl_b32 s36, s30, 7
    s_add_u32 m0, s29, 65536
    s_add_u32 s36, s36, s27
    buffer_load_dwordx4 v12, s[12:15], s36 offen lds
    buffer_load_dwordx4 v13, s[12:15], s36 offen offset:1024 lds
    s_mul_i32 s37, s30, 196608
    s_add_u32 s37, s37, s28
    s_add_u32 m0, s29, 73728
    s_nop 0
    buffer_load_dwordx4 v14, s[16:19], s37 offen lds
    buffer_load_dwordx4 v15, s[16:19], s37 offen offset:1024 lds
    s_add_u32 m0, s29, 81920
    s_add_u32 s37, s37, 1024
    buffer_load_dwordx4 v14, s[16:19], s37 offen lds
    buffer_load_dwordx4 v15, s[16:19], s37 offen offset:1024 lds
    s_add_u32 m0, s29, 90112
    s_add_u32 s37, s37, 1024
    buffer_load_dwordx4 v14, s[16:19], s37 offen lds
    buffer_load_dwordx4 v15, s[16:19], s37 offen offset:1024 lds
    s_add_u32 s30, s33, 3
    s_and_b32 s30, s30, 7
    s_lshl_b32 s36, s30, 7
    s_add_u32 m0, s29, 98304
    s_add_u32 s36, s36, s27
    buffer_load_dwordx4 v12, s[12:15], s36 offen lds
    buffer_load_dwordx4 v13, s[12:15], s36 offen offset:1024 lds
    s_mul_i32 s37, s30, 196608
    s_add_u32 s37, s37, s28
    s_add_u32 m0, s29, 106496
    s_nop 0
    buffer_load_dwordx4 v14, s[16:19], s37 offen lds
    buffer_load_dwordx4 v15, s[16:19], s37 offen offset:1024 lds
    s_add_u32 m0, s29, 114688
    s_add_u32 s37, s37, 1024
    buffer_load_dwordx4 v14, s[16:19], s37 offen lds
    buffer_load_dwordx4 v15, s[16:19], s37 offen offset:1024 lds
    s_add_u32 m0, s29, 122880
    s_add_u32 s37, s37, 1024
    buffer_load_dwordx4 v14, s[16:19], s37 offen lds
    buffer_load_dwordx4 v15, s[16:19], s37 offen offset:1024 lds
    s_waitcnt vmcnt(16)
    s_barrier
    s_add_u32 s30, s33, 4
    s_and_b32 s30, s30, 7
    s_lshl_b32 s36, s30, 7
    s_add_u32 m0, s29, 131072
    s_add_u32 s36, s36, s27
    buffer_load_dwordx4 v12, s[12:15], s36 offen lds
    buffer_load_dwordx4 v13, s[12:15], s36 offen offset:1024 lds
    s_mul_i32 s37, s30, 196608
    s_add_u32 s37, s37, s28
    s_add_u32 m0, s29, 139264
    s_nop 0
    buffer_load_dwordx4 v14, s[16:19], s37 offen lds
    buffer_load_dwordx4 v15, s[16:19], s37 offen offset:1024 lds
    s_add_u32 m0, s29, 147456
    s_add_u32 s37, s37, 1024
    buffer_load_dwordx4 v14, s[16:19], s37 offen lds
    buffer_load_dwordx4 v15, s[16:19], s37 offen offset:1024 lds
    s_add_u32 m0, s29, 155648
    s_add_u32 s37, s37, 1024
    buffer_load_dwordx4 v14, s[16:19], s37 offen lds
    buffer_load_dwordx4 v15, s[16:19], s37 offen offset:1024 lds
    s_waitcnt vmcnt(16)
    s_barrier
    s_add_u32 s30, s33, 5
    s_and_b32 s30, s30, 7
    s_lshl_b32 s36, s30, 7
    s_add_u32 m0, s29, 0
    s_add_u32 s36, s36, s27
    buffer_load_dwordx4 v12, s[12:15], s36 offen lds
    buffer_load_dwordx4 v13, s[12:15], s36 offen offset:1024 lds
    s_mul_i32 s37, s30, 196608
    s_add_u32 s37, s37, s28
    s_add_u32 m0, s29, 8192
    s_nop 0
    buffer_load_dwordx4 v14, s[16:19], s37 offen lds
    buffer_load_dwordx4 v15, s[16:19], s37 offen offset:1024 lds
    s_add_u32 m0, s29, 16384
    s_add_u32 s37, s37, 1024
    buffer_load_dwordx4 v14, s[16:19], s37 offen lds
    buffer_load_dwordx4 v15, s[16:19], s37 offen offset:1024 lds
    s_add_u32 m0, s29, 24576
    s_add_u32 s37, s37, 1024
    buffer_load_dwordx4 v14, s[16:19], s37 offen lds
    buffer_load_dwordx4 v15, s[16:19], s37 offen offset:1024 lds
    s_waitcnt vmcnt(16)
    s_barrier
    s_add_u32 s30, s33, 6
    s_and_b32 s30, s30, 7
    s_lshl_b32 s36, s30, 7
    s_add_u32 m0, s29, 32768
    s_add_u32 s36, s36, s27
    buffer_load_dwordx4 v12, s[12:15], s36 offen lds
    buffer_load_dwordx4 v13, s[12:15], s36 offen offset:1024 lds
    s_mul_i32 s37, s30, 196608
    s_add_u32 s37, s37, s28
    s_add_u32 m0, s29, 40960
    s_nop 0
    buffer_load_dwordx4 v14, s[16:19], s37 offen lds
    buffer_load_dwordx4 v15, s[16:19], s37 offen offset:1024 lds
    s_add_u32 m0, s29, 49152
    s_add_u32 s37, s37, 1024
    buffer_load_dwordx4 v14, s[16:19], s37 offen lds
    buffer_load_dwordx4 v15, s[16:19], s37 offen offset:1024 lds
    s_add_u32 m0, s29, 57344
    s_add_u32 s37, s37, 1024
    buffer_load_dwordx4 v14, s[16:19], s37 offen lds
    buffer_load_dwordx4 v15, s[16:19], s37 offen offset:1024 lds
    s_waitcnt vmcnt(16)
    s_barrier
    s_add_u32 s30, s33, 7
    s_and_b32 s30, s30, 7
    s_lshl_b32 s36, s30, 7
    s_add_u32 m0, s29, 65536
    s_add_u32 s36, s36, s27
    buffer_load_dwordx4 v12, s[12:15], s36 offen lds
    buffer_load_dwordx4 v13, s[12:15], s36 offen offset:1024 lds
    s_mul_i32 s37, s30, 196608
    s_add_u32 s37, s37, s28
    s_add_u32 m0, s29, 73728
    s_nop 0
    buffer_load_dwordx4 v14, s[16:19], s37 offen lds
    buffer_load_dwordx4 v15, s[16:19], s37 offen offset:1024 lds
    s_add_u32 m0, s29, 81920
    s_add_u32 s37, s37, 1024
    buffer_load_dwordx4 v14, s[16:19], s37 offen lds
    buffer_load_dwordx4 v15, s[16:19], s37 offen offset:1024 lds
    s_add_u32 m0, s29, 90112
    s_add_u32 s37, s37, 1024
    buffer_load_dwordx4 v14, s[16:19], s37 offen lds
    buffer_load_dwordx4 v15, s[16:19], s37 offen offset:1024 lds
    s_add_u32 s20, s8, 6291456
    s_addc_u32 s21, s9, 0
    s_mov_b32 s22, 12582912
    s_mov_b32 s23, 0x20000
    v_mov_b32 v8, 0
    v_mov_b32 v9, 0
    v_mov_b32 v10, 0
    v_mov_b32 v11, 0
    s_lshl_b32 s30, s2, 2
    s_add_u32 s30, s30, s24
    s_mul_i32 s30, s30, 12288
    v_lshlrev_b32 v5, 4, v1
    s_lshl_b32 s30, s2, 2
    s_add_u32 s30, s30, s24
    s_lshl_b32 s30, s30, 10
    s_add_u32 s20, s8, 18350080
    s_addc_u32 s21, s9, 0
    s_mov_b32 s22, 65536
    s_mov_b32 s23, 0x20000
    buffer_store_dwordx4 v[8:11], v5, s[20:23], s30 offen
    s_waitcnt vmcnt(17)
    s_barrier
    s_waitcnt vmcnt(9)
    s_barrier
    s_waitcnt vmcnt(1)
    s_barrier
    s_endpgm
qkv_kernel_compute:
    v_bfe_u32 v4, v2, 1, 3
    v_xor_b32 v4, v4, v3
    v_lshlrev_b32 v5, 7, v2
    s_lshl_b32 s30, s34, 12
    v_add_u32 v5, s30, v5
    v_bfe_u32 v7, v1, 2, 2
    v_lshl_add_u32 v6, v3, 3, v7
    v_lshlrev_b32 v6, 7, v6
    v_lshrrev_b32 v7, 1, v7
    v_xor_b32 v7, s35, v7
    v_lshl_add_u32 v6, v7, 6, v6
    v_bfe_u32 v7, v1, 4, 1
    v_lshl_add_u32 v6, v7, 5, v6
    v_and_b32 v7, 3, v1
    v_lshl_add_u32 v6, v7, 3, v6
    v_add_u32 v6, 8192, v6
    s_xor_b32 s30, s24, 0
    s_lshl_b32 s31, s30, 1
    v_xor_b32 v8, s31, v4
    v_lshl_add_u32 v16, v8, 4, v5
    s_lshl_b32 s31, s30, 11
    v_add_u32 v28, s31, v6
    v_add_u32 v20, 65536, v16
    v_add_u32 v32, 65536, v28
    v_add_u32 v24, 131072, v16
    v_add_u32 v36, 131072, v28
    s_xor_b32 s30, s24, 1
    s_lshl_b32 s31, s30, 1
    v_xor_b32 v8, s31, v4
    v_lshl_add_u32 v17, v8, 4, v5
    s_lshl_b32 s31, s30, 11
    v_add_u32 v29, s31, v6
    v_add_u32 v21, 65536, v17
    v_add_u32 v33, 65536, v29
    v_add_u32 v25, 131072, v17
    v_add_u32 v37, 131072, v29
    s_xor_b32 s30, s24, 2
    s_lshl_b32 s31, s30, 1
    v_xor_b32 v8, s31, v4
    v_lshl_add_u32 v18, v8, 4, v5
    s_lshl_b32 s31, s30, 11
    v_add_u32 v30, s31, v6
    v_add_u32 v22, 65536, v18
    v_add_u32 v34, 65536, v30
    v_add_u32 v26, 131072, v18
    v_add_u32 v38, 131072, v30
    s_xor_b32 s30, s24, 3
    s_lshl_b32 s31, s30, 1
    v_xor_b32 v8, s31, v4
    v_lshl_add_u32 v19, v8, 4, v5
    s_lshl_b32 s31, s30, 11
    v_add_u32 v31, s31, v6
    v_add_u32 v23, 65536, v19
    v_add_u32 v35, 65536, v31
    v_add_u32 v27, 131072, v19
    v_add_u32 v39, 131072, v31
    v_lshrrev_b32 v4, 2, v1
    v_lshrrev_b32 v5, 4, v1
    v_xor_b32 v4, v4, v5
    v_and_b32 v4, 1, v4
    v_add_u32 v4, -1, v4
    v_and_b32 v80, 0x3f803f80, v4
    v_mov_b32 v81, v80
    v_mov_b32 v82, v80
    v_mov_b32 v83, v80
    v_mov_b32 v148, 0
    v_mov_b32 v149, 0
    s_waitcnt lgkmcnt(0)
    s_barrier
    s_mov_b32 s20, s8
    s_mov_b32 s21, s9
    s_mov_b32 s22, 18350080
    s_mov_b32 s23, 0x20000
    ds_read_b128 v[40:43], v16 offset:0
    ds_read_b64_tr_b16 v[48:49], v28 offset:0
    ds_read_b64_tr_b16 v[50:51], v28 offset:512
    ds_read_b64_tr_b16 v[52:53], v28 offset:8192
    ds_read_b64_tr_b16 v[54:55], v28 offset:8704
    ds_read_b64_tr_b16 v[56:57], v28 offset:16384
    ds_read_b64_tr_b16 v[58:59], v28 offset:16896
    s_waitcnt lgkmcnt(4)
    v_mfma_f32_32x32x16_bf16 v[84:99], v[48:51], v[40:43], 0
    ds_read_b128 v[44:47], v17 offset:0
    ds_read_b64_tr_b16 v[60:61], v29 offset:0
    ds_read_b64_tr_b16 v[62:63], v29 offset:512
    v_lshlrev_b32 v72, 16, v40
    v_and_b32 v73, 0xffff0000, v40
    v_lshlrev_b32 v74, 16, v41
    v_and_b32 v75, 0xffff0000, v41
    s_waitcnt lgkmcnt(5)
    v_mfma_f32_32x32x16_bf16 v[100:115], v[52:55], v[40:43], 0
    ds_read_b64_tr_b16 v[64:65], v29 offset:8192
    ds_read_b64_tr_b16 v[66:67], v29 offset:8704
    v_lshlrev_b32 v76, 16, v42
    v_and_b32 v77, 0xffff0000, v42
    v_lshlrev_b32 v78, 16, v43
    v_and_b32 v79, 0xffff0000, v43
    s_waitcnt lgkmcnt(5)
    v_mfma_f32_32x32x16_bf16 v[116:131], v[40:43], v[56:59], 0
    ds_read_b64_tr_b16 v[68:69], v29 offset:16384
    ds_read_b64_tr_b16 v[70:71], v29 offset:16896
    v_fmac_f32 v148, v72, v72
    v_fmac_f32 v149, v73, v73
    v_fmac_f32 v148, v74, v74
    v_fmac_f32 v149, v75, v75
    v_mfma_f32_16x16x32_bf16 v[132:135], v[80:83], v[40:43], 0
    v_fmac_f32 v148, v76, v76
    v_fmac_f32 v149, v77, v77
    v_fmac_f32 v148, v78, v78
    v_fmac_f32 v149, v79, v79
    v_mfma_f32_16x16x32_bf16 v[136:139], v[80:83], v[48:51], 0
    v_mfma_f32_16x16x32_bf16 v[140:143], v[80:83], v[52:55], 0
    v_mfma_f32_16x16x32_bf16 v[144:147], v[80:83], v[56:59], 0
    s_waitcnt lgkmcnt(4)
    v_mfma_f32_32x32x16_bf16 v[84:99], v[60:63], v[44:47], v[84:99]
    ds_read_b128 v[40:43], v18 offset:0
    ds_read_b64_tr_b16 v[48:49], v30 offset:0
    ds_read_b64_tr_b16 v[50:51], v30 offset:512
    s_waitcnt lgkmcnt(5)
    v_mfma_f32_32x32x16_bf16 v[100:115], v[64:67], v[44:47], v[100:115]
    ds_read_b64_tr_b16 v[52:53], v30 offset:8192
    ds_read_b64_tr_b16 v[54:55], v30 offset:8704
    s_waitcnt lgkmcnt(5)
    v_mfma_f32_32x32x16_bf16 v[116:131], v[44:47], v[68:71], v[116:131]
    ds_read_b64_tr_b16 v[56:57], v30 offset:16384
    ds_read_b64_tr_b16 v[58:59], v30 offset:16896
    v_mfma_f32_16x16x32_bf16 v[136:139], v[80:83], v[60:63], v[136:139]
    v_mfma_f32_16x16x32_bf16 v[140:143], v[80:83], v[64:67], v[140:143]
    v_mfma_f32_16x16x32_bf16 v[144:147], v[80:83], v[68:71], v[144:147]
    s_waitcnt lgkmcnt(4)
    v_mfma_f32_32x32x16_bf16 v[84:99], v[48:51], v[40:43], v[84:99]
    ds_read_b128 v[44:47], v19 offset:0
    ds_read_b64_tr_b16 v[60:61], v31 offset:0
    ds_read_b64_tr_b16 v[62:63], v31 offset:512
    v_lshlrev_b32 v72, 16, v40
    v_and_b32 v73, 0xffff0000, v40
    v_lshlrev_b32 v74, 16, v41
    v_and_b32 v75, 0xffff0000, v41
    s_waitcnt lgkmcnt(5)
    v_mfma_f32_32x32x16_bf16 v[100:115], v[52:55], v[40:43], v[100:115]
    ds_read_b64_tr_b16 v[64:65], v31 offset:8192
    ds_read_b64_tr_b16 v[66:67], v31 offset:8704
    v_lshlrev_b32 v76, 16, v42
    v_and_b32 v77, 0xffff0000, v42
    v_lshlrev_b32 v78, 16, v43
    v_and_b32 v79, 0xffff0000, v43
    s_waitcnt lgkmcnt(5)
    v_mfma_f32_32x32x16_bf16 v[116:131], v[40:43], v[56:59], v[116:131]
    ds_read_b64_tr_b16 v[68:69], v31 offset:16384
    ds_read_b64_tr_b16 v[70:71], v31 offset:16896
    v_fmac_f32 v148, v72, v72
    v_fmac_f32 v149, v73, v73
    v_fmac_f32 v148, v74, v74
    v_fmac_f32 v149, v75, v75
    v_mfma_f32_16x16x32_bf16 v[132:135], v[80:83], v[40:43], v[132:135]
    v_fmac_f32 v148, v76, v76
    v_fmac_f32 v149, v77, v77
    v_fmac_f32 v148, v78, v78
    v_fmac_f32 v149, v79, v79
    s_waitcnt lgkmcnt(4)
    v_mfma_f32_32x32x16_bf16 v[84:99], v[60:63], v[44:47], v[84:99]
    s_waitcnt lgkmcnt(0)
    s_barrier
    ds_read_b128 v[40:43], v16 offset:32768
    ds_read_b64_tr_b16 v[48:49], v28 offset:32768
    ds_read_b64_tr_b16 v[50:51], v28 offset:33280
    v_mfma_f32_32x32x16_bf16 v[100:115], v[64:67], v[44:47], v[100:115]
    ds_read_b64_tr_b16 v[52:53], v28 offset:40960
    ds_read_b64_tr_b16 v[54:55], v28 offset:41472
    v_mfma_f32_32x32x16_bf16 v[116:131], v[44:47], v[68:71], v[116:131]
    ds_read_b64_tr_b16 v[56:57], v28 offset:49152
    ds_read_b64_tr_b16 v[58:59], v28 offset:49664
    s_waitcnt lgkmcnt(4)
    v_mfma_f32_32x32x16_bf16 v[84:99], v[48:51], v[40:43], v[84:99]
    ds_read_b128 v[44:47], v17 offset:32768
    ds_read_b64_tr_b16 v[60:61], v29 offset:32768
    ds_read_b64_tr_b16 v[62:63], v29 offset:33280
    v_lshlrev_b32 v72, 16, v40
    v_and_b32 v73, 0xffff0000, v40
    v_lshlrev_b32 v74, 16, v41
    v_and_b32 v75, 0xffff0000, v41
    s_waitcnt lgkmcnt(5)
    v_mfma_f32_32x32x16_bf16 v[100:115], v[52:55], v[40:43], v[100:115]
    ds_read_b64_tr_b16 v[64:65], v29 offset:40960
    ds_read_b64_tr_b16 v[66:67], v29 offset:41472
    v_lshlrev_b32 v76, 16, v42
    v_and_b32 v77, 0xffff0000, v42
    v_lshlrev_b32 v78, 16, v43
    v_and_b32 v79, 0xffff0000, v43
    s_waitcnt lgkmcnt(5)
    v_mfma_f32_32x32x16_bf16 v[116:131], v[40:43], v[56:59], v[116:131]
    ds_read_b64_tr_b16 v[68:69], v29 offset:49152
    ds_read_b64_tr_b16 v[70:71], v29 offset:49664
    v_fmac_f32 v148, v72, v72
    v_fmac_f32 v149, v73, v73
    v_fmac_f32 v148, v74, v74
    v_fmac_f32 v149, v75, v75
    v_mfma_f32_16x16x32_bf16 v[132:135], v[80:83], v[40:43], v[132:135]
    v_fmac_f32 v148, v76, v76
    v_fmac_f32 v149, v77, v77
    v_fmac_f32 v148, v78, v78
    v_fmac_f32 v149, v79, v79
    v_mfma_f32_16x16x32_bf16 v[136:139], v[80:83], v[48:51], v[136:139]
    v_mfma_f32_16x16x32_bf16 v[140:143], v[80:83], v[52:55], v[140:143]
    v_mfma_f32_16x16x32_bf16 v[144:147], v[80:83], v[56:59], v[144:147]
    s_waitcnt lgkmcnt(4)
    v_mfma_f32_32x32x16_bf16 v[84:99], v[60:63], v[44:47], v[84:99]
    ds_read_b128 v[40:43], v18 offset:32768
    ds_read_b64_tr_b16 v[48:49], v30 offset:32768
    ds_read_b64_tr_b16 v[50:51], v30 offset:33280
    s_waitcnt lgkmcnt(5)
    v_mfma_f32_32x32x16_bf16 v[100:115], v[64:67], v[44:47], v[100:115]
    ds_read_b64_tr_b16 v[52:53], v30 offset:40960
    ds_read_b64_tr_b16 v[54:55], v30 offset:41472
    s_waitcnt lgkmcnt(5)
    v_mfma_f32_32x32x16_bf16 v[116:131], v[44:47], v[68:71], v[116:131]
    ds_read_b64_tr_b16 v[56:57], v30 offset:49152
    ds_read_b64_tr_b16 v[58:59], v30 offset:49664
    v_mfma_f32_16x16x32_bf16 v[136:139], v[80:83], v[60:63], v[136:139]
    v_mfma_f32_16x16x32_bf16 v[140:143], v[80:83], v[64:67], v[140:143]
    v_mfma_f32_16x16x32_bf16 v[144:147], v[80:83], v[68:71], v[144:147]
    s_waitcnt lgkmcnt(4)
    v_mfma_f32_32x32x16_bf16 v[84:99], v[48:51], v[40:43], v[84:99]
    ds_read_b128 v[44:47], v19 offset:32768
    ds_read_b64_tr_b16 v[60:61], v31 offset:32768
    ds_read_b64_tr_b16 v[62:63], v31 offset:33280
    v_lshlrev_b32 v72, 16, v40
    v_and_b32 v73, 0xffff0000, v40
    v_lshlrev_b32 v74, 16, v41
    v_and_b32 v75, 0xffff0000, v41
    s_waitcnt lgkmcnt(5)
    v_mfma_f32_32x32x16_bf16 v[100:115], v[52:55], v[40:43], v[100:115]
    ds_read_b64_tr_b16 v[64:65], v31 offset:40960
    ds_read_b64_tr_b16 v[66:67], v31 offset:41472
    v_lshlrev_b32 v76, 16, v42
    v_and_b32 v77, 0xffff0000, v42
    v_lshlrev_b32 v78, 16, v43
    v_and_b32 v79, 0xffff0000, v43
    s_waitcnt lgkmcnt(5)
    v_mfma_f32_32x32x16_bf16 v[116:131], v[40:43], v[56:59], v[116:131]
    ds_read_b64_tr_b16 v[68:69], v31 offset:49152
    ds_read_b64_tr_b16 v[70:71], v31 offset:49664
    v_fmac_f32 v148, v72, v72
    v_fmac_f32 v149, v73, v73
    v_fmac_f32 v148, v74, v74
    v_fmac_f32 v149, v75, v75
    v_mfma_f32_16x16x32_bf16 v[132:135], v[80:83], v[40:43], v[132:135]
    v_fmac_f32 v148, v76, v76
    v_fmac_f32 v149, v77, v77
    v_fmac_f32 v148, v78, v78
    v_fmac_f32 v149, v79, v79
    s_waitcnt lgkmcnt(4)
    v_mfma_f32_32x32x16_bf16 v[84:99], v[60:63], v[44:47], v[84:99]
    s_waitcnt lgkmcnt(0)
    s_barrier
    ds_read_b128 v[40:43], v20 offset:0
    ds_read_b64_tr_b16 v[48:49], v32 offset:0
    ds_read_b64_tr_b16 v[50:51], v32 offset:512
    v_mfma_f32_32x32x16_bf16 v[100:115], v[64:67], v[44:47], v[100:115]
    ds_read_b64_tr_b16 v[52:53], v32 offset:8192
    ds_read_b64_tr_b16 v[54:55], v32 offset:8704
    v_mfma_f32_32x32x16_bf16 v[116:131], v[44:47], v[68:71], v[116:131]
    ds_read_b64_tr_b16 v[56:57], v32 offset:16384
    ds_read_b64_tr_b16 v[58:59], v32 offset:16896
    s_waitcnt lgkmcnt(4)
    v_mfma_f32_32x32x16_bf16 v[84:99], v[48:51], v[40:43], v[84:99]
    ds_read_b128 v[44:47], v21 offset:0
    ds_read_b64_tr_b16 v[60:61], v33 offset:0
    ds_read_b64_tr_b16 v[62:63], v33 offset:512
    v_lshlrev_b32 v72, 16, v40
    v_and_b32 v73, 0xffff0000, v40
    v_lshlrev_b32 v74, 16, v41
    v_and_b32 v75, 0xffff0000, v41
    s_waitcnt lgkmcnt(5)
    v_mfma_f32_32x32x16_bf16 v[100:115], v[52:55], v[40:43], v[100:115]
    ds_read_b64_tr_b16 v[64:65], v33 offset:8192
    ds_read_b64_tr_b16 v[66:67], v33 offset:8704
    v_lshlrev_b32 v76, 16, v42
    v_and_b32 v77, 0xffff0000, v42
    v_lshlrev_b32 v78, 16, v43
    v_and_b32 v79, 0xffff0000, v43
    s_waitcnt lgkmcnt(5)
    v_mfma_f32_32x32x16_bf16 v[116:131], v[40:43], v[56:59], v[116:131]
    ds_read_b64_tr_b16 v[68:69], v33 offset:16384
    ds_read_b64_tr_b16 v[70:71], v33 offset:16896
    v_fmac_f32 v148, v72, v72
    v_fmac_f32 v149, v73, v73
    v_fmac_f32 v148, v74, v74
    v_fmac_f32 v149, v75, v75
    v_mfma_f32_16x16x32_bf16 v[132:135], v[80:83], v[40:43], v[132:135]
    v_fmac_f32 v148, v76, v76
    v_fmac_f32 v149, v77, v77
    v_fmac_f32 v148, v78, v78
    v_fmac_f32 v149, v79, v79
    v_mfma_f32_16x16x32_bf16 v[136:139], v[80:83], v[48:51], v[136:139]
    v_mfma_f32_16x16x32_bf16 v[140:143], v[80:83], v[52:55], v[140:143]
    v_mfma_f32_16x16x32_bf16 v[144:147], v[80:83], v[56:59], v[144:147]
    s_waitcnt lgkmcnt(4)
    v_mfma_f32_32x32x16_bf16 v[84:99], v[60:63], v[44:47], v[84:99]
    ds_read_b128 v[40:43], v22 offset:0
    ds_read_b64_tr_b16 v[48:49], v34 offset:0
    ds_read_b64_tr_b16 v[50:51], v34 offset:512
    s_waitcnt lgkmcnt(5)
    v_mfma_f32_32x32x16_bf16 v[100:115], v[64:67], v[44:47], v[100:115]
    ds_read_b64_tr_b16 v[52:53], v34 offset:8192
    ds_read_b64_tr_b16 v[54:55], v34 offset:8704
    s_waitcnt lgkmcnt(5)
    v_mfma_f32_32x32x16_bf16 v[116:131], v[44:47], v[68:71], v[116:131]
    ds_read_b64_tr_b16 v[56:57], v34 offset:16384
    ds_read_b64_tr_b16 v[58:59], v34 offset:16896
    v_mfma_f32_16x16x32_bf16 v[136:139], v[80:83], v[60:63], v[136:139]
    v_mfma_f32_16x16x32_bf16 v[140:143], v[80:83], v[64:67], v[140:143]
    v_mfma_f32_16x16x32_bf16 v[144:147], v[80:83], v[68:71], v[144:147]
    s_waitcnt lgkmcnt(4)
    v_mfma_f32_32x32x16_bf16 v[84:99], v[48:51], v[40:43], v[84:99]
    ds_read_b128 v[44:47], v23 offset:0
    ds_read_b64_tr_b16 v[60:61], v35 offset:0
    ds_read_b64_tr_b16 v[62:63], v35 offset:512
    v_lshlrev_b32 v72, 16, v40
    v_and_b32 v73, 0xffff0000, v40
    v_lshlrev_b32 v74, 16, v41
    v_and_b32 v75, 0xffff0000, v41
    s_waitcnt lgkmcnt(5)
    v_mfma_f32_32x32x16_bf16 v[100:115], v[52:55], v[40:43], v[100:115]
    ds_read_b64_tr_b16 v[64:65], v35 offset:8192
    ds_read_b64_tr_b16 v[66:67], v35 offset:8704
    v_lshlrev_b32 v76, 16, v42
    v_and_b32 v77, 0xffff0000, v42
    v_lshlrev_b32 v78, 16, v43
    v_and_b32 v79, 0xffff0000, v43
    s_waitcnt lgkmcnt(5)
    v_mfma_f32_32x32x16_bf16 v[116:131], v[40:43], v[56:59], v[116:131]
    ds_read_b64_tr_b16 v[68:69], v35 offset:16384
    ds_read_b64_tr_b16 v[70:71], v35 offset:16896
    v_fmac_f32 v148, v72, v72
    v_fmac_f32 v149, v73, v73
    v_fmac_f32 v148, v74, v74
    v_fmac_f32 v149, v75, v75
    v_mfma_f32_16x16x32_bf16 v[132:135], v[80:83], v[40:43], v[132:135]
    v_fmac_f32 v148, v76, v76
    v_fmac_f32 v149, v77, v77
    v_fmac_f32 v148, v78, v78
    v_fmac_f32 v149, v79, v79
    s_waitcnt lgkmcnt(4)
    v_mfma_f32_32x32x16_bf16 v[84:99], v[60:63], v[44:47], v[84:99]
    s_waitcnt lgkmcnt(0)
    s_barrier
    ds_read_b128 v[40:43], v20 offset:32768
    ds_read_b64_tr_b16 v[48:49], v32 offset:32768
    ds_read_b64_tr_b16 v[50:51], v32 offset:33280
    v_mfma_f32_32x32x16_bf16 v[100:115], v[64:67], v[44:47], v[100:115]
    ds_read_b64_tr_b16 v[52:53], v32 offset:40960
    ds_read_b64_tr_b16 v[54:55], v32 offset:41472
    v_mfma_f32_32x32x16_bf16 v[116:131], v[44:47], v[68:71], v[116:131]
    ds_read_b64_tr_b16 v[56:57], v32 offset:49152
    ds_read_b64_tr_b16 v[58:59], v32 offset:49664
    s_waitcnt lgkmcnt(4)
    v_mfma_f32_32x32x16_bf16 v[84:99], v[48:51], v[40:43], v[84:99]
    ds_read_b128 v[44:47], v21 offset:32768
    ds_read_b64_tr_b16 v[60:61], v33 offset:32768
    ds_read_b64_tr_b16 v[62:63], v33 offset:33280
    v_lshlrev_b32 v72, 16, v40
    v_and_b32 v73, 0xffff0000, v40
    v_lshlrev_b32 v74, 16, v41
    v_and_b32 v75, 0xffff0000, v41
    s_waitcnt lgkmcnt(5)
    v_mfma_f32_32x32x16_bf16 v[100:115], v[52:55], v[40:43], v[100:115]
    ds_read_b64_tr_b16 v[64:65], v33 offset:40960
    ds_read_b64_tr_b16 v[66:67], v33 offset:41472
    v_lshlrev_b32 v76, 16, v42
    v_and_b32 v77, 0xffff0000, v42
    v_lshlrev_b32 v78, 16, v43
    v_and_b32 v79, 0xffff0000, v43
    s_waitcnt lgkmcnt(5)
    v_mfma_f32_32x32x16_bf16 v[116:131], v[40:43], v[56:59], v[116:131]
    ds_read_b64_tr_b16 v[68:69], v33 offset:49152
    ds_read_b64_tr_b16 v[70:71], v33 offset:49664
    v_fmac_f32 v148, v72, v72
    v_fmac_f32 v149, v73, v73
    v_fmac_f32 v148, v74, v74
    v_fmac_f32 v149, v75, v75
    v_mfma_f32_16x16x32_bf16 v[132:135], v[80:83], v[40:43], v[132:135]
    v_fmac_f32 v148, v76, v76
    v_fmac_f32 v149, v77, v77
    v_fmac_f32 v148, v78, v78
    v_fmac_f32 v149, v79, v79
    v_mfma_f32_16x16x32_bf16 v[136:139], v[80:83], v[48:51], v[136:139]
    v_mfma_f32_16x16x32_bf16 v[140:143], v[80:83], v[52:55], v[140:143]
    v_mfma_f32_16x16x32_bf16 v[144:147], v[80:83], v[56:59], v[144:147]
    s_waitcnt lgkmcnt(4)
    v_mfma_f32_32x32x16_bf16 v[84:99], v[60:63], v[44:47], v[84:99]
    ds_read_b128 v[40:43], v22 offset:32768
    ds_read_b64_tr_b16 v[48:49], v34 offset:32768
    ds_read_b64_tr_b16 v[50:51], v34 offset:33280
    s_waitcnt lgkmcnt(5)
    v_mfma_f32_32x32x16_bf16 v[100:115], v[64:67], v[44:47], v[100:115]
    ds_read_b64_tr_b16 v[52:53], v34 offset:40960
    ds_read_b64_tr_b16 v[54:55], v34 offset:41472
    s_waitcnt lgkmcnt(5)
    v_mfma_f32_32x32x16_bf16 v[116:131], v[44:47], v[68:71], v[116:131]
    ds_read_b64_tr_b16 v[56:57], v34 offset:49152
    ds_read_b64_tr_b16 v[58:59], v34 offset:49664
    v_mfma_f32_16x16x32_bf16 v[136:139], v[80:83], v[60:63], v[136:139]
    v_mfma_f32_16x16x32_bf16 v[140:143], v[80:83], v[64:67], v[140:143]
    v_mfma_f32_16x16x32_bf16 v[144:147], v[80:83], v[68:71], v[144:147]
    s_waitcnt lgkmcnt(4)
    v_mfma_f32_32x32x16_bf16 v[84:99], v[48:51], v[40:43], v[84:99]
    ds_read_b128 v[44:47], v23 offset:32768
    ds_read_b64_tr_b16 v[60:61], v35 offset:32768
    ds_read_b64_tr_b16 v[62:63], v35 offset:33280
    v_lshlrev_b32 v72, 16, v40
    v_and_b32 v73, 0xffff0000, v40
    v_lshlrev_b32 v74, 16, v41
    v_and_b32 v75, 0xffff0000, v41
    s_waitcnt lgkmcnt(5)
    v_mfma_f32_32x32x16_bf16 v[100:115], v[52:55], v[40:43], v[100:115]
    ds_read_b64_tr_b16 v[64:65], v35 offset:40960
    ds_read_b64_tr_b16 v[66:67], v35 offset:41472
    v_lshlrev_b32 v76, 16, v42
    v_and_b32 v77, 0xffff0000, v42
    v_lshlrev_b32 v78, 16, v43
    v_and_b32 v79, 0xffff0000, v43
    s_waitcnt lgkmcnt(5)
    v_mfma_f32_32x32x16_bf16 v[116:131], v[40:43], v[56:59], v[116:131]
    ds_read_b64_tr_b16 v[68:69], v35 offset:49152
    ds_read_b64_tr_b16 v[70:71], v35 offset:49664
    v_fmac_f32 v148, v72, v72
    v_fmac_f32 v149, v73, v73
    v_fmac_f32 v148, v74, v74
    v_fmac_f32 v149, v75, v75
    v_mfma_f32_16x16x32_bf16 v[132:135], v[80:83], v[40:43], v[132:135]
    v_fmac_f32 v148, v76, v76
    v_fmac_f32 v149, v77, v77
    v_fmac_f32 v148, v78, v78
    v_fmac_f32 v149, v79, v79
    s_waitcnt lgkmcnt(4)
    v_mfma_f32_32x32x16_bf16 v[84:99], v[60:63], v[44:47], v[84:99]
    s_waitcnt lgkmcnt(0)
    s_barrier
    ds_read_b128 v[40:43], v24 offset:0
    ds_read_b64_tr_b16 v[48:49], v36 offset:0
    ds_read_b64_tr_b16 v[50:51], v36 offset:512
    v_mfma_f32_32x32x16_bf16 v[100:115], v[64:67], v[44:47], v[100:115]
    ds_read_b64_tr_b16 v[52:53], v36 offset:8192
    ds_read_b64_tr_b16 v[54:55], v36 offset:8704
    v_mfma_f32_32x32x16_bf16 v[116:131], v[44:47], v[68:71], v[116:131]
    ds_read_b64_tr_b16 v[56:57], v36 offset:16384
    ds_read_b64_tr_b16 v[58:59], v36 offset:16896
    s_waitcnt lgkmcnt(4)
    v_mfma_f32_32x32x16_bf16 v[84:99], v[48:51], v[40:43], v[84:99]
    ds_read_b128 v[44:47], v25 offset:0
    ds_read_b64_tr_b16 v[60:61], v37 offset:0
    ds_read_b64_tr_b16 v[62:63], v37 offset:512
    v_lshlrev_b32 v72, 16, v40
    v_and_b32 v73, 0xffff0000, v40
    v_lshlrev_b32 v74, 16, v41
    v_and_b32 v75, 0xffff0000, v41
    s_waitcnt lgkmcnt(5)
    v_mfma_f32_32x32x16_bf16 v[100:115], v[52:55], v[40:43], v[100:115]
    ds_read_b64_tr_b16 v[64:65], v37 offset:8192
    ds_read_b64_tr_b16 v[66:67], v37 offset:8704
    v_lshlrev_b32 v76, 16, v42
    v_and_b32 v77, 0xffff0000, v42
    v_lshlrev_b32 v78, 16, v43
    v_and_b32 v79, 0xffff0000, v43
    s_waitcnt lgkmcnt(5)
    v_mfma_f32_32x32x16_bf16 v[116:131], v[40:43], v[56:59], v[116:131]
    ds_read_b64_tr_b16 v[68:69], v37 offset:16384
    ds_read_b64_tr_b16 v[70:71], v37 offset:16896
    v_fmac_f32 v148, v72, v72
    v_fmac_f32 v149, v73, v73
    v_fmac_f32 v148, v74, v74
    v_fmac_f32 v149, v75, v75
    v_mfma_f32_16x16x32_bf16 v[132:135], v[80:83], v[40:43], v[132:135]
    v_fmac_f32 v148, v76, v76
    v_fmac_f32 v149, v77, v77
    v_fmac_f32 v148, v78, v78
    v_fmac_f32 v149, v79, v79
    v_mfma_f32_16x16x32_bf16 v[136:139], v[80:83], v[48:51], v[136:139]
    v_mfma_f32_16x16x32_bf16 v[140:143], v[80:83], v[52:55], v[140:143]
    v_mfma_f32_16x16x32_bf16 v[144:147], v[80:83], v[56:59], v[144:147]
    s_waitcnt lgkmcnt(4)
    v_mfma_f32_32x32x16_bf16 v[84:99], v[60:63], v[44:47], v[84:99]
    ds_read_b128 v[40:43], v26 offset:0
    ds_read_b64_tr_b16 v[48:49], v38 offset:0
    ds_read_b64_tr_b16 v[50:51], v38 offset:512
    s_waitcnt lgkmcnt(5)
    v_mfma_f32_32x32x16_bf16 v[100:115], v[64:67], v[44:47], v[100:115]
    ds_read_b64_tr_b16 v[52:53], v38 offset:8192
    ds_read_b64_tr_b16 v[54:55], v38 offset:8704
    s_waitcnt lgkmcnt(5)
    v_mfma_f32_32x32x16_bf16 v[116:131], v[44:47], v[68:71], v[116:131]
    ds_read_b64_tr_b16 v[56:57], v38 offset:16384
    ds_read_b64_tr_b16 v[58:59], v38 offset:16896
    v_mfma_f32_16x16x32_bf16 v[136:139], v[80:83], v[60:63], v[136:139]
    v_mfma_f32_16x16x32_bf16 v[140:143], v[80:83], v[64:67], v[140:143]
    v_mfma_f32_16x16x32_bf16 v[144:147], v[80:83], v[68:71], v[144:147]
    s_waitcnt lgkmcnt(4)
    v_mfma_f32_32x32x16_bf16 v[84:99], v[48:51], v[40:43], v[84:99]
    ds_read_b128 v[44:47], v27 offset:0
    ds_read_b64_tr_b16 v[60:61], v39 offset:0
    ds_read_b64_tr_b16 v[62:63], v39 offset:512
    v_lshlrev_b32 v72, 16, v40
    v_and_b32 v73, 0xffff0000, v40
    v_lshlrev_b32 v74, 16, v41
    v_and_b32 v75, 0xffff0000, v41
    s_waitcnt lgkmcnt(5)
    v_mfma_f32_32x32x16_bf16 v[100:115], v[52:55], v[40:43], v[100:115]
    ds_read_b64_tr_b16 v[64:65], v39 offset:8192
    ds_read_b64_tr_b16 v[66:67], v39 offset:8704
    v_lshlrev_b32 v76, 16, v42
    v_and_b32 v77, 0xffff0000, v42
    v_lshlrev_b32 v78, 16, v43
    v_and_b32 v79, 0xffff0000, v43
    s_waitcnt lgkmcnt(5)
    v_mfma_f32_32x32x16_bf16 v[116:131], v[40:43], v[56:59], v[116:131]
    ds_read_b64_tr_b16 v[68:69], v39 offset:16384
    ds_read_b64_tr_b16 v[70:71], v39 offset:16896
    v_fmac_f32 v148, v72, v72
    v_fmac_f32 v149, v73, v73
    v_fmac_f32 v148, v74, v74
    v_fmac_f32 v149, v75, v75
    v_mfma_f32_16x16x32_bf16 v[132:135], v[80:83], v[40:43], v[132:135]
    v_fmac_f32 v148, v76, v76
    v_fmac_f32 v149, v77, v77
    v_fmac_f32 v148, v78, v78
    v_fmac_f32 v149, v79, v79
    s_waitcnt lgkmcnt(4)
    v_mfma_f32_32x32x16_bf16 v[84:99], v[60:63], v[44:47], v[84:99]
    s_waitcnt lgkmcnt(0)
    s_barrier
    ds_read_b128 v[40:43], v16 offset:0
    ds_read_b64_tr_b16 v[48:49], v28 offset:0
    ds_read_b64_tr_b16 v[50:51], v28 offset:512
    v_mfma_f32_32x32x16_bf16 v[100:115], v[64:67], v[44:47], v[100:115]
    ds_read_b64_tr_b16 v[52:53], v28 offset:8192
    ds_read_b64_tr_b16 v[54:55], v28 offset:8704
    v_mfma_f32_32x32x16_bf16 v[116:131], v[44:47], v[68:71], v[116:131]
    ds_read_b64_tr_b16 v[56:57], v28 offset:16384
    ds_read_b64_tr_b16 v[58:59], v28 offset:16896
    s_waitcnt lgkmcnt(4)
    v_mfma_f32_32x32x16_bf16 v[84:99], v[48:51], v[40:43], v[84:99]
    ds_read_b128 v[44:47], v17 offset:0
    ds_read_b64_tr_b16 v[60:61], v29 offset:0
    ds_read_b64_tr_b16 v[62:63], v29 offset:512
    v_lshlrev_b32 v72, 16, v40
    v_and_b32 v73, 0xffff0000, v40
    v_lshlrev_b32 v74, 16, v41
    v_and_b32 v75, 0xffff0000, v41
    s_waitcnt lgkmcnt(5)
    v_mfma_f32_32x32x16_bf16 v[100:115], v[52:55], v[40:43], v[100:115]
    ds_read_b64_tr_b16 v[64:65], v29 offset:8192
    ds_read_b64_tr_b16 v[66:67], v29 offset:8704
    v_lshlrev_b32 v76, 16, v42
    v_and_b32 v77, 0xffff0000, v42
    v_lshlrev_b32 v78, 16, v43
    v_and_b32 v79, 0xffff0000, v43
    s_waitcnt lgkmcnt(5)
    v_mfma_f32_32x32x16_bf16 v[116:131], v[40:43], v[56:59], v[116:131]
    ds_read_b64_tr_b16 v[68:69], v29 offset:16384
    ds_read_b64_tr_b16 v[70:71], v29 offset:16896
    v_fmac_f32 v148, v72, v72
    v_fmac_f32 v149, v73, v73
    v_fmac_f32 v148, v74, v74
    v_fmac_f32 v149, v75, v75
    v_mfma_f32_16x16x32_bf16 v[132:135], v[80:83], v[40:43], v[132:135]
    v_fmac_f32 v148, v76, v76
    v_fmac_f32 v149, v77, v77
    v_fmac_f32 v148, v78, v78
    v_fmac_f32 v149, v79, v79
    v_mfma_f32_16x16x32_bf16 v[136:139], v[80:83], v[48:51], v[136:139]
    v_mfma_f32_16x16x32_bf16 v[140:143], v[80:83], v[52:55], v[140:143]
    v_mfma_f32_16x16x32_bf16 v[144:147], v[80:83], v[56:59], v[144:147]
    s_waitcnt lgkmcnt(4)
    v_mfma_f32_32x32x16_bf16 v[84:99], v[60:63], v[44:47], v[84:99]
    ds_read_b128 v[40:43], v18 offset:0
    ds_read_b64_tr_b16 v[48:49], v30 offset:0
    ds_read_b64_tr_b16 v[50:51], v30 offset:512
    s_waitcnt lgkmcnt(5)
    v_mfma_f32_32x32x16_bf16 v[100:115], v[64:67], v[44:47], v[100:115]
    ds_read_b64_tr_b16 v[52:53], v30 offset:8192
    ds_read_b64_tr_b16 v[54:55], v30 offset:8704
    s_waitcnt lgkmcnt(5)
    v_mfma_f32_32x32x16_bf16 v[116:131], v[44:47], v[68:71], v[116:131]
    ds_read_b64_tr_b16 v[56:57], v30 offset:16384
    ds_read_b64_tr_b16 v[58:59], v30 offset:16896
    v_mfma_f32_16x16x32_bf16 v[136:139], v[80:83], v[60:63], v[136:139]
    v_mfma_f32_16x16x32_bf16 v[140:143], v[80:83], v[64:67], v[140:143]
    v_mfma_f32_16x16x32_bf16 v[144:147], v[80:83], v[68:71], v[144:147]
    s_waitcnt lgkmcnt(4)
    v_mfma_f32_32x32x16_bf16 v[84:99], v[48:51], v[40:43], v[84:99]
    ds_read_b128 v[44:47], v19 offset:0
    ds_read_b64_tr_b16 v[60:61], v31 offset:0
    ds_read_b64_tr_b16 v[62:63], v31 offset:512
    v_lshlrev_b32 v72, 16, v40
    v_and_b32 v73, 0xffff0000, v40
    v_lshlrev_b32 v74, 16, v41
    v_and_b32 v75, 0xffff0000, v41
    s_waitcnt lgkmcnt(5)
    v_mfma_f32_32x32x16_bf16 v[100:115], v[52:55], v[40:43], v[100:115]
    ds_read_b64_tr_b16 v[64:65], v31 offset:8192
    ds_read_b64_tr_b16 v[66:67], v31 offset:8704
    v_lshlrev_b32 v76, 16, v42
    v_and_b32 v77, 0xffff0000, v42
    v_lshlrev_b32 v78, 16, v43
    v_and_b32 v79, 0xffff0000, v43
    s_waitcnt lgkmcnt(5)
    v_mfma_f32_32x32x16_bf16 v[116:131], v[40:43], v[56:59], v[116:131]
    ds_read_b64_tr_b16 v[68:69], v31 offset:16384
    ds_read_b64_tr_b16 v[70:71], v31 offset:16896
    v_fmac_f32 v148, v72, v72
    v_fmac_f32 v149, v73, v73
    v_fmac_f32 v148, v74, v74
    v_fmac_f32 v149, v75, v75
    v_mfma_f32_16x16x32_bf16 v[132:135], v[80:83], v[40:43], v[132:135]
    v_fmac_f32 v148, v76, v76
    v_fmac_f32 v149, v77, v77
    v_fmac_f32 v148, v78, v78
    v_fmac_f32 v149, v79, v79
    s_waitcnt lgkmcnt(4)
    v_mfma_f32_32x32x16_bf16 v[84:99], v[60:63], v[44:47], v[84:99]
    s_waitcnt lgkmcnt(0)
    s_barrier
    ds_read_b128 v[40:43], v16 offset:32768
    ds_read_b64_tr_b16 v[48:49], v28 offset:32768
    ds_read_b64_tr_b16 v[50:51], v28 offset:33280
    v_mfma_f32_32x32x16_bf16 v[100:115], v[64:67], v[44:47], v[100:115]
    ds_read_b64_tr_b16 v[52:53], v28 offset:40960
    ds_read_b64_tr_b16 v[54:55], v28 offset:41472
    v_mfma_f32_32x32x16_bf16 v[116:131], v[44:47], v[68:71], v[116:131]
    ds_read_b64_tr_b16 v[56:57], v28 offset:49152
    ds_read_b64_tr_b16 v[58:59], v28 offset:49664
    s_waitcnt lgkmcnt(4)
    v_mfma_f32_32x32x16_bf16 v[84:99], v[48:51], v[40:43], v[84:99]
    ds_read_b128 v[44:47], v17 offset:32768
    ds_read_b64_tr_b16 v[60:61], v29 offset:32768
    ds_read_b64_tr_b16 v[62:63], v29 offset:33280
    v_lshlrev_b32 v72, 16, v40
    v_and_b32 v73, 0xffff0000, v40
    v_lshlrev_b32 v74, 16, v41
    v_and_b32 v75, 0xffff0000, v41
    s_waitcnt lgkmcnt(5)
    v_mfma_f32_32x32x16_bf16 v[100:115], v[52:55], v[40:43], v[100:115]
    ds_read_b64_tr_b16 v[64:65], v29 offset:40960
    ds_read_b64_tr_b16 v[66:67], v29 offset:41472
    v_lshlrev_b32 v76, 16, v42
    v_and_b32 v77, 0xffff0000, v42
    v_lshlrev_b32 v78, 16, v43
    v_and_b32 v79, 0xffff0000, v43
    s_waitcnt lgkmcnt(5)
    v_mfma_f32_32x32x16_bf16 v[116:131], v[40:43], v[56:59], v[116:131]
    ds_read_b64_tr_b16 v[68:69], v29 offset:49152
    ds_read_b64_tr_b16 v[70:71], v29 offset:49664
    v_fmac_f32 v148, v72, v72
    v_fmac_f32 v149, v73, v73
    v_fmac_f32 v148, v74, v74
    v_fmac_f32 v149, v75, v75
    v_mfma_f32_16x16x32_bf16 v[132:135], v[80:83], v[40:43], v[132:135]
    v_fmac_f32 v148, v76, v76
    v_fmac_f32 v149, v77, v77
    v_fmac_f32 v148, v78, v78
    v_fmac_f32 v149, v79, v79
    v_mfma_f32_16x16x32_bf16 v[136:139], v[80:83], v[48:51], v[136:139]
    v_mfma_f32_16x16x32_bf16 v[140:143], v[80:83], v[52:55], v[140:143]
    v_mfma_f32_16x16x32_bf16 v[144:147], v[80:83], v[56:59], v[144:147]
    s_waitcnt lgkmcnt(4)
    v_mfma_f32_32x32x16_bf16 v[84:99], v[60:63], v[44:47], v[84:99]
    ds_read_b128 v[40:43], v18 offset:32768
    ds_read_b64_tr_b16 v[48:49], v30 offset:32768
    ds_read_b64_tr_b16 v[50:51], v30 offset:33280
    s_waitcnt lgkmcnt(5)
    v_mfma_f32_32x32x16_bf16 v[100:115], v[64:67], v[44:47], v[100:115]
    ds_read_b64_tr_b16 v[52:53], v30 offset:40960
    ds_read_b64_tr_b16 v[54:55], v30 offset:41472
    s_waitcnt lgkmcnt(5)
    v_mfma_f32_32x32x16_bf16 v[116:131], v[44:47], v[68:71], v[116:131]
    ds_read_b64_tr_b16 v[56:57], v30 offset:49152
    ds_read_b64_tr_b16 v[58:59], v30 offset:49664
    v_mfma_f32_16x16x32_bf16 v[136:139], v[80:83], v[60:63], v[136:139]
    v_mfma_f32_16x16x32_bf16 v[140:143], v[80:83], v[64:67], v[140:143]
    v_mfma_f32_16x16x32_bf16 v[144:147], v[80:83], v[68:71], v[144:147]
    s_waitcnt lgkmcnt(4)
    v_mfma_f32_32x32x16_bf16 v[84:99], v[48:51], v[40:43], v[84:99]
    ds_read_b128 v[44:47], v19 offset:32768
    ds_read_b64_tr_b16 v[60:61], v31 offset:32768
    ds_read_b64_tr_b16 v[62:63], v31 offset:33280
    v_lshlrev_b32 v72, 16, v40
    v_and_b32 v73, 0xffff0000, v40
    v_lshlrev_b32 v74, 16, v41
    v_and_b32 v75, 0xffff0000, v41
    s_waitcnt lgkmcnt(5)
    v_mfma_f32_32x32x16_bf16 v[100:115], v[52:55], v[40:43], v[100:115]
    ds_read_b64_tr_b16 v[64:65], v31 offset:40960
    ds_read_b64_tr_b16 v[66:67], v31 offset:41472
    v_lshlrev_b32 v76, 16, v42
    v_and_b32 v77, 0xffff0000, v42
    v_lshlrev_b32 v78, 16, v43
    v_and_b32 v79, 0xffff0000, v43
    s_waitcnt lgkmcnt(5)
    v_mfma_f32_32x32x16_bf16 v[116:131], v[40:43], v[56:59], v[116:131]
    ds_read_b64_tr_b16 v[68:69], v31 offset:49152
    ds_read_b64_tr_b16 v[70:71], v31 offset:49664
    v_fmac_f32 v148, v72, v72
    v_fmac_f32 v149, v73, v73
    v_fmac_f32 v148, v74, v74
    v_fmac_f32 v149, v75, v75
    v_mfma_f32_16x16x32_bf16 v[132:135], v[80:83], v[40:43], v[132:135]
    v_fmac_f32 v148, v76, v76
    v_fmac_f32 v149, v77, v77
    v_fmac_f32 v148, v78, v78
    v_fmac_f32 v149, v79, v79
    s_waitcnt lgkmcnt(4)
    v_mfma_f32_32x32x16_bf16 v[84:99], v[60:63], v[44:47], v[84:99]
    s_waitcnt lgkmcnt(0)
    s_barrier
    ds_read_b128 v[40:43], v20 offset:0
    ds_read_b64_tr_b16 v[48:49], v32 offset:0
    ds_read_b64_tr_b16 v[50:51], v32 offset:512
    v_mfma_f32_32x32x16_bf16 v[100:115], v[64:67], v[44:47], v[100:115]
    ds_read_b64_tr_b16 v[52:53], v32 offset:8192
    ds_read_b64_tr_b16 v[54:55], v32 offset:8704
    v_mfma_f32_32x32x16_bf16 v[116:131], v[44:47], v[68:71], v[116:131]
    ds_read_b64_tr_b16 v[56:57], v32 offset:16384
    ds_read_b64_tr_b16 v[58:59], v32 offset:16896
    s_waitcnt lgkmcnt(4)
    v_mfma_f32_32x32x16_bf16 v[84:99], v[48:51], v[40:43], v[84:99]
    ds_read_b128 v[44:47], v21 offset:0
    ds_read_b64_tr_b16 v[60:61], v33 offset:0
    ds_read_b64_tr_b16 v[62:63], v33 offset:512
    v_lshlrev_b32 v72, 16, v40
    v_and_b32 v73, 0xffff0000, v40
    v_lshlrev_b32 v74, 16, v41
    v_and_b32 v75, 0xffff0000, v41
    s_waitcnt lgkmcnt(5)
    v_mfma_f32_32x32x16_bf16 v[100:115], v[52:55], v[40:43], v[100:115]
    ds_read_b64_tr_b16 v[64:65], v33 offset:8192
    ds_read_b64_tr_b16 v[66:67], v33 offset:8704
    v_lshlrev_b32 v76, 16, v42
    v_and_b32 v77, 0xffff0000, v42
    v_lshlrev_b32 v78, 16, v43
    v_and_b32 v79, 0xffff0000, v43
    s_waitcnt lgkmcnt(5)
    v_mfma_f32_32x32x16_bf16 v[116:131], v[40:43], v[56:59], v[116:131]
    ds_read_b64_tr_b16 v[68:69], v33 offset:16384
    ds_read_b64_tr_b16 v[70:71], v33 offset:16896
    v_fmac_f32 v148, v72, v72
    v_fmac_f32 v149, v73, v73
    v_fmac_f32 v148, v74, v74
    v_fmac_f32 v149, v75, v75
    v_mfma_f32_16x16x32_bf16 v[132:135], v[80:83], v[40:43], v[132:135]
    v_fmac_f32 v148, v76, v76
    v_fmac_f32 v149, v77, v77
    v_fmac_f32 v148, v78, v78
    v_fmac_f32 v149, v79, v79
    v_mfma_f32_16x16x32_bf16 v[136:139], v[80:83], v[48:51], v[136:139]
    v_mfma_f32_16x16x32_bf16 v[140:143], v[80:83], v[52:55], v[140:143]
    v_mfma_f32_16x16x32_bf16 v[144:147], v[80:83], v[56:59], v[144:147]
    s_waitcnt lgkmcnt(4)
    v_mfma_f32_32x32x16_bf16 v[84:99], v[60:63], v[44:47], v[84:99]
    ds_read_b128 v[40:43], v22 offset:0
    ds_read_b64_tr_b16 v[48:49], v34 offset:0
    ds_read_b64_tr_b16 v[50:51], v34 offset:512
    s_waitcnt lgkmcnt(5)
    v_mfma_f32_32x32x16_bf16 v[100:115], v[64:67], v[44:47], v[100:115]
    ds_read_b64_tr_b16 v[52:53], v34 offset:8192
    ds_read_b64_tr_b16 v[54:55], v34 offset:8704
    s_waitcnt lgkmcnt(5)
    v_mfma_f32_32x32x16_bf16 v[116:131], v[44:47], v[68:71], v[116:131]
    ds_read_b64_tr_b16 v[56:57], v34 offset:16384
    ds_read_b64_tr_b16 v[58:59], v34 offset:16896
    v_mfma_f32_16x16x32_bf16 v[136:139], v[80:83], v[60:63], v[136:139]
    v_mfma_f32_16x16x32_bf16 v[140:143], v[80:83], v[64:67], v[140:143]
    v_mfma_f32_16x16x32_bf16 v[144:147], v[80:83], v[68:71], v[144:147]
    s_waitcnt lgkmcnt(4)
    v_mfma_f32_32x32x16_bf16 v[84:99], v[48:51], v[40:43], v[84:99]
    ds_read_b128 v[44:47], v23 offset:0
    ds_read_b64_tr_b16 v[60:61], v35 offset:0
    ds_read_b64_tr_b16 v[62:63], v35 offset:512
    v_lshlrev_b32 v72, 16, v40
    v_and_b32 v73, 0xffff0000, v40
    v_lshlrev_b32 v74, 16, v41
    v_and_b32 v75, 0xffff0000, v41
    s_waitcnt lgkmcnt(5)
    v_mfma_f32_32x32x16_bf16 v[100:115], v[52:55], v[40:43], v[100:115]
    ds_read_b64_tr_b16 v[64:65], v35 offset:8192
    ds_read_b64_tr_b16 v[66:67], v35 offset:8704
    v_lshlrev_b32 v76, 16, v42
    v_and_b32 v77, 0xffff0000, v42
    v_lshlrev_b32 v78, 16, v43
    v_and_b32 v79, 0xffff0000, v43
    s_waitcnt lgkmcnt(5)
    v_mfma_f32_32x32x16_bf16 v[116:131], v[40:43], v[56:59], v[116:131]
    ds_read_b64_tr_b16 v[68:69], v35 offset:16384
    ds_read_b64_tr_b16 v[70:71], v35 offset:16896
    v_fmac_f32 v148, v72, v72
    v_fmac_f32 v149, v73, v73
    v_fmac_f32 v148, v74, v74
    v_fmac_f32 v149, v75, v75
    v_mfma_f32_16x16x32_bf16 v[132:135], v[80:83], v[40:43], v[132:135]
    v_fmac_f32 v148, v76, v76
    v_fmac_f32 v149, v77, v77
    v_fmac_f32 v148, v78, v78
    v_fmac_f32 v149, v79, v79
    s_waitcnt lgkmcnt(4)
    v_mfma_f32_32x32x16_bf16 v[84:99], v[60:63], v[44:47], v[84:99]
    s_waitcnt lgkmcnt(2)
    v_mfma_f32_32x32x16_bf16 v[100:115], v[64:67], v[44:47], v[100:115]
    s_waitcnt lgkmcnt(0)
    v_mfma_f32_32x32x16_bf16 v[116:131], v[44:47], v[68:71], v[116:131]
qkv_kernel_epi:
    v_add_f32 v155, v148, v149
    s_lshl_b32 s30, s24, 10
    v_lshlrev_b32 v150, 2, v2
    v_add_u32 v151, s30, v150
    ds_write_b32 v151, v136 offset:0
    ds_write_b32 v151, v140 offset:128
    ds_write_b32 v151, v144 offset:256
    v_mov_b32 v4, v155
    s_nop 1
    v_permlane32_swap_b32 v155, v4
    s_nop 1
    v_add_f32 v155, v155, v4
    v_mov_b32 v154, v132
    v_add_u32 v152, v151, v150
    ds_write_b64 v152, v[154:155] offset:384
    v_xor_b32 v152, 1024, v152
    v_xor_b32 v150, 2048, v151
    v_lshlrev_b32 v153, 4, v3
    v_add_u32 v153, s30, v153
    v_xor_b32 v4, 2048, v153
    s_waitcnt lgkmcnt(0)
    s_barrier
    ds_read_b64 v[156:157], v152 offset:384
    ds_read_b32 v158, v150 offset:256
    ds_read_b128 v[16:19], v153 offset:0
    ds_read_b128 v[20:23], v153 offset:32
    ds_read_b128 v[24:27], v153 offset:64
    ds_read_b128 v[28:31], v153 offset:96
    ds_read_b128 v[32:35], v153 offset:128
    ds_read_b128 v[36:39], v153 offset:160
    ds_read_b128 v[40:43], v153 offset:192
    ds_read_b128 v[44:47], v153 offset:224
    ds_read_b128 v[64:67], v4 offset:128
    ds_read_b128 v[68:71], v4 offset:160
    ds_read_b128 v[72:75], v4 offset:192
    ds_read_b128 v[76:79], v4 offset:224
    s_waitcnt lgkmcnt(12)
    v_add_f32 v154, v154, v156
    v_add_f32 v155, v155, v157
    v_add_f32 v158, v158, v144
    ds_read_b128 v[48:51], v4 offset:0
    ds_read_b128 v[52:55], v4 offset:32
    ds_read_b128 v[56:59], v4 offset:64
    ds_read_b128 v[60:63], v4 offset:96
    v_mul_f32 v192, 0x3b000000, v154
    v_mul_f32 v155, 0x3b000000, v155
    v_fma_f32 v194, -v192, v192, v155
    v_max_f32 v194, 0, v194
    v_cvt_pk_bf16_f32 v192, v192, v192
    v_and_b32 v192, 0xffff0000, v192
    v_cvt_pk_bf16_f32 v194, v194, v194
    v_and_b32 v194, 0xffff0000, v194
    v_add_f32 v194, 0x3727c5ac, v194
    v_cvt_pk_bf16_f32 v194, v194, v194
    v_and_b32 v194, 0xffff0000, v194
    v_sqrt_f32 v194, v194
    s_nop 0
    v_cvt_pk_bf16_f32 v194, v194, v194
    v_and_b32 v194, 0xffff0000, v194
    v_rcp_f32 v194, v194
    s_nop 0
    v_sub_f32 v192, 0, v192
    ds_write_b32 v151, v192 offset:640
    ds_write_b32 v151, v194 offset:768
    v_mul_f32 v196, 0x3eb8aa3b, v194
    v_lshlrev_b32 v198, 4, v1
    v_bfe_u32 v4, v1, 4, 1
    v_lshlrev_b32 v199, 16, v4
    v_lshl_add_u32 v199, v3, 8, v199
    v_and_b32 v4, 15, v1
    v_lshl_add_u32 v199, v4, 4, v199
    s_lshl_b32 s30, s26, 1
    s_add_u32 s30, s30, s35
    s_lshl_b32 s30, s30, 17
    s_lshl_b32 s31, s25, 1
    s_add_u32 s31, s31, s34
    s_lshl_b32 s31, s31, 10
    s_add_u32 s30, s30, s31
    s_waitcnt lgkmcnt(0)
    ds_read_b128 v[160:163], v153 offset:640
    ds_read_b128 v[164:167], v153 offset:672
    ds_read_b128 v[168:171], v153 offset:704
    ds_read_b128 v[172:175], v153 offset:736
    ds_read_b128 v[176:179], v153 offset:768
    ds_read_b128 v[180:183], v153 offset:800
    ds_read_b128 v[184:187], v153 offset:832
    ds_read_b128 v[188:191], v153 offset:864
    v_pk_add_f32 v[32:33], v[32:33], v[64:65]
    v_pk_add_f32 v[34:35], v[34:35], v[66:67]
    v_pk_add_f32 v[36:37], v[36:37], v[68:69]
    v_pk_add_f32 v[38:39], v[38:39], v[70:71]
    v_pk_add_f32 v[40:41], v[40:41], v[72:73]
    v_pk_add_f32 v[42:43], v[42:43], v[74:75]
    v_pk_add_f32 v[44:45], v[44:45], v[76:77]
    v_pk_add_f32 v[46:47], v[46:47], v[78:79]
    v_pk_fma_f32 v[100:101], v[32:33], v[192:193], v[100:101] op_sel_hi:[1,0,1]
    v_pk_fma_f32 v[102:103], v[34:35], v[192:193], v[102:103] op_sel_hi:[1,0,1]
    v_pk_fma_f32 v[104:105], v[36:37], v[192:193], v[104:105] op_sel_hi:[1,0,1]
    v_pk_fma_f32 v[106:107], v[38:39], v[192:193], v[106:107] op_sel_hi:[1,0,1]
    v_pk_fma_f32 v[108:109], v[40:41], v[192:193], v[108:109] op_sel_hi:[1,0,1]
    v_pk_fma_f32 v[110:111], v[42:43], v[192:193], v[110:111] op_sel_hi:[1,0,1]
    v_pk_fma_f32 v[112:113], v[44:45], v[192:193], v[112:113] op_sel_hi:[1,0,1]
    v_pk_fma_f32 v[114:115], v[46:47], v[192:193], v[114:115] op_sel_hi:[1,0,1]
    v_pk_mul_f32 v[100:101], v[100:101], v[194:195] op_sel_hi:[1,0]
    v_pk_mul_f32 v[102:103], v[102:103], v[194:195] op_sel_hi:[1,0]
    v_pk_mul_f32 v[104:105], v[104:105], v[194:195] op_sel_hi:[1,0]
    v_pk_mul_f32 v[106:107], v[106:107], v[194:195] op_sel_hi:[1,0]
    v_pk_mul_f32 v[108:109], v[108:109], v[194:195] op_sel_hi:[1,0]
    v_pk_mul_f32 v[110:111], v[110:111], v[194:195] op_sel_hi:[1,0]
    v_pk_mul_f32 v[112:113], v[112:113], v[194:195] op_sel_hi:[1,0]
    v_pk_mul_f32 v[114:115], v[114:115], v[194:195] op_sel_hi:[1,0]
    v_cvt_pk_bf16_f32 v208, v100, v101
    v_cvt_pk_bf16_f32 v209, v102, v103
    v_cvt_pk_bf16_f32 v210, v104, v105
    v_cvt_pk_bf16_f32 v211, v106, v107
    v_cvt_pk_bf16_f32 v212, v108, v109
    v_cvt_pk_bf16_f32 v213, v110, v111
    v_cvt_pk_bf16_f32 v214, v112, v113
    v_cvt_pk_bf16_f32 v215, v114, v115
    s_add_u32 s31, s30, 2097152
    s_add_u32 s32, s30, 2162688
    buffer_store_dwordx4 v[208:211], v198, s[20:23], s31 offen sc1
    buffer_store_dwordx4 v[212:215], v198, s[20:23], s32 offen sc1
    v_pk_add_f32 v[16:17], v[16:17], v[48:49]
    v_pk_add_f32 v[18:19], v[18:19], v[50:51]
    v_pk_add_f32 v[20:21], v[20:21], v[52:53]
    v_pk_add_f32 v[22:23], v[22:23], v[54:55]
    v_pk_add_f32 v[24:25], v[24:25], v[56:57]
    v_pk_add_f32 v[26:27], v[26:27], v[58:59]
    v_pk_add_f32 v[28:29], v[28:29], v[60:61]
    v_pk_add_f32 v[30:31], v[30:31], v[62:63]
    v_pk_fma_f32 v[84:85], v[16:17], v[192:193], v[84:85] op_sel_hi:[1,0,1]
    v_pk_fma_f32 v[86:87], v[18:19], v[192:193], v[86:87] op_sel_hi:[1,0,1]
    v_pk_fma_f32 v[88:89], v[20:21], v[192:193], v[88:89] op_sel_hi:[1,0,1]
    v_pk_fma_f32 v[90:91], v[22:23], v[192:193], v[90:91] op_sel_hi:[1,0,1]
    v_pk_fma_f32 v[92:93], v[24:25], v[192:193], v[92:93] op_sel_hi:[1,0,1]
    v_pk_fma_f32 v[94:95], v[26:27], v[192:193], v[94:95] op_sel_hi:[1,0,1]
    v_pk_fma_f32 v[96:97], v[28:29], v[192:193], v[96:97] op_sel_hi:[1,0,1]
    v_pk_fma_f32 v[98:99], v[30:31], v[192:193], v[98:99] op_sel_hi:[1,0,1]
    v_pk_mul_f32 v[84:85], v[84:85], v[196:197] op_sel_hi:[1,0]
    v_pk_mul_f32 v[86:87], v[86:87], v[196:197] op_sel_hi:[1,0]
    v_pk_mul_f32 v[88:89], v[88:89], v[196:197] op_sel_hi:[1,0]
    v_pk_mul_f32 v[90:91], v[90:91], v[196:197] op_sel_hi:[1,0]
    v_pk_mul_f32 v[92:93], v[92:93], v[196:197] op_sel_hi:[1,0]
    v_pk_mul_f32 v[94:95], v[94:95], v[196:197] op_sel_hi:[1,0]
    v_pk_mul_f32 v[96:97], v[96:97], v[196:197] op_sel_hi:[1,0]
    v_pk_mul_f32 v[98:99], v[98:99], v[196:197] op_sel_hi:[1,0]
    v_cvt_pk_bf16_f32 v200, v84, v85
    v_cvt_pk_bf16_f32 v201, v86, v87
    v_cvt_pk_bf16_f32 v202, v88, v89
    v_cvt_pk_bf16_f32 v203, v90, v91
    v_cvt_pk_bf16_f32 v204, v92, v93
    v_cvt_pk_bf16_f32 v205, v94, v95
    v_cvt_pk_bf16_f32 v206, v96, v97
    v_cvt_pk_bf16_f32 v207, v98, v99
    s_add_u32 s31, s30, 0
    s_add_u32 s32, s30, 65536
    buffer_store_dwordx4 v[200:203], v198, s[20:23], s31 offen sc1
    buffer_store_dwordx4 v[204:207], v198, s[20:23], s32 offen sc1
    v_pk_mul_f32 v[16:17], v[84:85], v[100:101]
    v_pk_fma_f32 v[16:17], v[86:87], v[102:103], v[16:17]
    v_pk_fma_f32 v[16:17], v[88:89], v[104:105], v[16:17]
    v_pk_fma_f32 v[16:17], v[90:91], v[106:107], v[16:17]
    v_pk_mul_f32 v[18:19], v[92:93], v[108:109]
    v_pk_fma_f32 v[18:19], v[94:95], v[110:111], v[18:19]
    v_pk_fma_f32 v[18:19], v[96:97], v[112:113], v[18:19]
    v_pk_fma_f32 v[18:19], v[98:99], v[114:115], v[18:19]
    v_add_f32 v16, v16, v17
    v_add_f32 v17, v18, v19
    s_lshr_b32 s31, s30, 3
    v_lshlrev_b32 v18, 2, v2
    v_permlane32_swap_b32 v16, v17
    v_lshl_add_u32 v18, v3, 13, v18
    s_add_u32 s31, s31, 18087936
    v_add_f32 v16, v16, v17
    v_sub_f32 v16, 0, v16
    buffer_store_dword v16, v18, s[20:23], s31 offen
    v_mov_b32 v224, v158
    s_waitcnt lgkmcnt(0)
    v_pk_fma_f32 v[116:117], v[160:161], v[224:225], v[116:117] op_sel_hi:[1,0,1]
    v_pk_fma_f32 v[118:119], v[162:163], v[224:225], v[118:119] op_sel_hi:[1,0,1]
    v_pk_fma_f32 v[120:121], v[164:165], v[224:225], v[120:121] op_sel_hi:[1,0,1]
    v_pk_fma_f32 v[122:123], v[166:167], v[224:225], v[122:123] op_sel_hi:[1,0,1]
    v_pk_fma_f32 v[124:125], v[168:169], v[224:225], v[124:125] op_sel_hi:[1,0,1]
    v_pk_fma_f32 v[126:127], v[170:171], v[224:225], v[126:127] op_sel_hi:[1,0,1]
    v_pk_fma_f32 v[128:129], v[172:173], v[224:225], v[128:129] op_sel_hi:[1,0,1]
    v_pk_fma_f32 v[130:131], v[174:175], v[224:225], v[130:131] op_sel_hi:[1,0,1]
    v_pk_mul_f32 v[116:117], v[116:117], v[176:177]
    v_pk_mul_f32 v[118:119], v[118:119], v[178:179]
    v_pk_mul_f32 v[120:121], v[120:121], v[180:181]
    v_pk_mul_f32 v[122:123], v[122:123], v[182:183]
    v_pk_mul_f32 v[124:125], v[124:125], v[184:185]
    v_pk_mul_f32 v[126:127], v[126:127], v[186:187]
    v_pk_mul_f32 v[128:129], v[128:129], v[188:189]
    v_pk_mul_f32 v[130:131], v[130:131], v[190:191]
    v_cvt_pk_bf16_f32 v216, v116, v117
    v_cvt_pk_bf16_f32 v217, v118, v119
    v_cvt_pk_bf16_f32 v218, v120, v121
    v_cvt_pk_bf16_f32 v219, v122, v123
    v_cvt_pk_bf16_f32 v220, v124, v125
    v_cvt_pk_bf16_f32 v221, v126, v127
    v_cvt_pk_bf16_f32 v222, v128, v129
    v_cvt_pk_bf16_f32 v223, v130, v131
    s_add_u32 s31, s30, 4194304
    buffer_store_dwordx4 v[216:219], v199, s[20:23], s31 offen sc1
    buffer_store_dwordx4 v[220:223], v199, s[20:23], s31 offen offset:512 sc1
qkv_kernel_end:
    s_endpgm
.globl block_kernel
.p2align 8
.type block_kernel,@function
block_kernel:
    s_cmp_ge_u32 s2, 256
    s_cbranch_scc1 block_kernel_end
    s_load_dwordx2 s[4:5], s[0:1], 64
    s_load_dwordx2 s[6:7], s[0:1], 0
    s_load_dwordx2 s[8:9], s[0:1], 16
    s_load_dwordx2 s[10:11], s[0:1], 48
    s_load_dwordx4 s[12:15], s[0:1], 32
    v_and_b32 v1, 63, v0
    v_and_b32 v2, 31, v0
    v_bfe_u32 v3, v0, 5, 1
    v_lshrrev_b32 v6, 6, v0
    s_and_b32 s39, s2, 7
    v_readfirstlane_b32 s36, v6
    s_lshr_b32 s40, s2, 3
    s_getreg_b32 s41, hwreg(HW_REG_XCC_ID, 0, 4)
    s_lshr_b32 s38, s36, 2
    s_and_b32 s37, s36, 3
    s_add_u32 s41, s41, 1
    s_mov_b32 s3, s39
    s_mov_b32 s2, s40
    v_lshlrev_b32 v4, 4, v1
    s_lshl_b32 s46, s3, 3
    s_lshl_b32 s43, s37, 1
    s_add_u32 s46, s46, s43
    s_add_u32 s46, s46, s38
    s_lshl_b32 s42, s2, 16
    s_and_b32 s43, s36, 1
    s_lshl_b32 s47, s43, 16
    s_lshl_b32 s48, s43, 21
    s_bfe_u32 s43, s36, 0x10001
    s_lshl_b32 s43, s43, 15
    s_lshl_b32 s44, s38, 10
    s_add_u32 s43, s43, s44
    s_add_u32 s47, s47, s43
    s_add_u32 s48, s48, s43
    s_add_u32 s48, s48, s42
    s_add_u32 s48, s48, 2097152
    s_lshl_b32 s43, s46, 10
    s_add_u32 s43, s43, s42
    s_xor_b32 s44, s43, 1024
    s_lshl_b32 s45, s39, 12
    s_add_u32 s45, s45, 18350080
    s_waitcnt lgkmcnt(0)
    s_mov_b32 s16, s4
    s_mov_b32 s17, s5
    s_mov_b32 s18, 18350080
    s_mov_b32 s19, 0x20000
    buffer_load_dwordx4 v[10:13], v4, s[16:19], s43 offen
    buffer_load_dwordx4 v[14:17], v4, s[16:19], s44 offen
    v_lshlrev_b32 v6, 2, v2
    s_lshr_b32 s43, s43, 3
    s_add_u32 s43, s43, 18087936
    buffer_load_dword v56, v6, s[16:19], s43 offen
    s_lshr_b32 s44, s44, 3
    s_add_u32 s44, s44, 18087936
    buffer_load_dword v72, v6, s[16:19], s44 offen
    s_add_u32 m0, s47, 0
    s_add_u32 s42, s48, 0
    buffer_load_dwordx4 v4, s[16:19], s42 offen lds
    s_add_u32 m0, s47, 2048
    s_add_u32 s42, s48, 2048
    buffer_load_dwordx4 v4, s[16:19], s42 offen lds
    s_add_u32 s28, s4, s45
    s_addc_u32 s29, s5, 0
    s_mov_b32 s30, 4096
    s_mov_b32 s31, 0x20000
    v_and_b32 v6, 11, v0
    v_cmp_eq_u32 vcc, 0, v6
    v_mov_b32 v7, 0x3f803f80
    v_lshlrev_b32 v6, 4, v0
    v_cndmask_b32 v24, 0, v7, vcc
    v_and_b32 v6, 4095, v6
    v_mov_b32 v25, v24
    v_mov_b32 v26, v24
    v_mov_b32 v27, v24
    v_add_u32 v6, 131072, v6
    ds_write_b128 v6, v[24:27]
    v_mov_b32 v6, 154112
    v_mov_b32 v8, 0
    v_mov_b32 v9, 0
    ds_write_b64 v6, v[8:9]
    ds_write_b64 v6, v[8:9] offset:8
    s_mov_b32 s20, s8
    s_mov_b32 s21, s9
    s_mov_b32 s22, 524288
    s_mov_b32 s23, 0x20000
    s_mov_b32 s24, s12
    s_mov_b32 s25, s13
    s_mov_b32 s26, 1835008
    s_mov_b32 s27, 0x20000
    s_lshl_b32 s32, s37, 15
    s_lshl_b32 s42, s38, 18
    s_add_u32 s32, s32, s42
    s_and_b32 s42, s40, 7
    s_lshl_b32 s42, s42, 7
    s_add_u32 s32, s32, s42
    s_cmp_ge_u32 s40, 14
    s_cselect_b32 s43, 14, 0
    s_sub_u32 s43, s40, s43
    s_lshl_b32 s33, s43, 8
    s_mul_i32 s43, s37, 458752
    s_add_u32 s33, s33, s43
    s_xor_b32 s43, s38, 1
    s_lshl_b32 s43, s43, 7
    s_add_u32 s33, s33, s43
    s_mul_i32 s42, s40, 57344
    s_min_u32 s43, s36, 6
    s_lshl_b32 s43, s43, 13
    s_add_u32 s42, s42, s43
    s_add_u32 s34, s14, s42
    s_addc_u32 s35, s15, 0
    s_lshl_b32 s42, s38, 15
    v_add_u32 v18, s42, v4
    v_and_b32 v6, 15, v1
    v_lshlrev_b32 v6, 4, v6
    v_lshl_add_u32 v6, v3, 8, v6
    v_bfe_u32 v7, v1, 4, 1
    v_xor_b32 v8, 1, v7
    v_lshlrev_b32 v20, 12, v8
    v_mul_u32_u24 v8, s42, v8
    v_lshl_add_u32 v19, v7, 16, v6
    v_add_u32 v19, v19, v8
    v_add_u32 v19, 65536, v19
    v_mov_b32 v88, 0
    v_mov_b32 v89, 0
    v_mov_b32 v90, 0
    v_mov_b32 v91, 0
    v_mov_b32 v92, 0
    v_mov_b32 v93, 0
    v_mov_b32 v94, 0
    v_mov_b32 v95, 0
    v_mov_b32 v96, 0
    v_mov_b32 v97, 0
    v_mov_b32 v98, 0
    v_mov_b32 v99, 0
    v_mov_b32 v100, 0
    v_mov_b32 v101, 0
    v_mov_b32 v102, 0
    v_mov_b32 v103, 0
    v_mov_b32 v124, 0
    v_mov_b32 v125, 0
    v_mov_b32 v126, 0
    v_mov_b32 v127, 0
    v_mov_b32 v104, 0
    v_mov_b32 v105, 0
    v_mov_b32 v106, 0
    v_mov_b32 v107, 0
    v_mov_b32 v108, 0
    v_mov_b32 v109, 0
    v_mov_b32 v110, 0
    v_mov_b32 v111, 0
    v_mov_b32 v112, 0
    v_mov_b32 v113, 0
    v_mov_b32 v114, 0
    v_mov_b32 v115, 0
    v_mov_b32 v116, 0
    v_mov_b32 v117, 0
    v_mov_b32 v118, 0
    v_mov_b32 v119, 0
    v_mov_b32 v132, 0
    v_mov_b32 v133, 0
    v_mov_b32 v134, 0
    v_mov_b32 v135, 0
    v_bfe_u32 v6, v1, 4, 1
    v_lshlrev_b32 v6, 2, v6
    v_and_b32 v7, 7, v1
    v_xor_b32 v6, v6, v7
    v_lshlrev_b32 v6, 4, v6
    v_lshrrev_b32 v21, 3, v1
    v_lshl_add_u32 v8, v21, 10, v6
    v_mul_u32_u24 v9, 3584, v21
    v_add_u32 v9, v9, v6
    v_lshrrev_b32 v6, 4, v1
    v_xor_b32 v7, v7, v6
    s_and_b32 s42, s36, 1
    s_lshl_b32 s42, s42, 2
    v_xor_b32 v7, s42, v7
    v_lshlrev_b32 v7, 4, v7
    v_lshl_add_u32 v7, v21, 10, v7
    s_waitcnt vmcnt(1) lgkmcnt(0)
    s_barrier
    s_add_u32 m0, s47, 4096
    s_add_u32 s42, s48, 4096
    buffer_load_dwordx4 v4, s[16:19], s42 offen lds
    s_add_u32 m0, s47, 6144
    s_add_u32 s42, s48, 6144
    buffer_load_dwordx4 v4, s[16:19], s42 offen lds
    ds_read_b128 v[136:139], v18
    ds_read_b128 v[144:147], v19 offset:512
    ds_read_b128 v[140:143], v19
    v_mov_b32 v57, v56
    v_pk_mov_b32 v[58:59], v[56:57], v[56:57]
    v_pk_mov_b32 v[60:61], v[56:57], v[56:57]
    v_pk_mov_b32 v[62:63], v[56:57], v[56:57]
    v_pk_mov_b32 v[64:65], v[56:57], v[56:57]
    v_pk_mov_b32 v[66:67], v[56:57], v[56:57]
    v_pk_mov_b32 v[68:69], v[56:57], v[56:57]
    v_pk_mov_b32 v[70:71], v[56:57], v[56:57]
    s_waitcnt lgkmcnt(2)
    s_nop 0
    v_mfma_f32_32x32x16_bf16 v[24:39], v[136:139], v[10:13], v[56:71]
    v_mov_b32 v73, v72
    v_pk_mov_b32 v[74:75], v[72:73], v[72:73]
    v_pk_mov_b32 v[76:77], v[72:73], v[72:73]
    v_pk_mov_b32 v[78:79], v[72:73], v[72:73]
    v_pk_mov_b32 v[80:81], v[72:73], v[72:73]
    v_pk_mov_b32 v[82:83], v[72:73], v[72:73]
    v_pk_mov_b32 v[84:85], v[72:73], v[72:73]
    v_pk_mov_b32 v[86:87], v[72:73], v[72:73]
    s_waitcnt lgkmcnt(0)
    s_nop 0
    s_setprio 2
    v_mfma_f32_32x32x16_bf16 v[40:55], v[136:139], v[14:17], v[72:87]
    v_exp_f32 v24, v24
    v_exp_f32 v25, v25
    v_exp_f32 v26, v26
    v_mfma_f32_32x32x16_bf16 v[104:119], v[144:147], v[132:135], v[104:119]
    ds_read_b128 v[144:147], v19 offset:512
    ds_read_b128 v[136:139], v18 offset:1024
    v_exp_f32 v27, v27
    v_exp_f32 v28, v28
    v_exp_f32 v29, v29
    v_exp_f32 v30, v30
    v_exp_f32 v31, v31
    v_cvt_pk_bf16_f32 v120, v24, v25
    v_cvt_pk_bf16_f32 v121, v26, v27
    v_cvt_pk_bf16_f32 v122, v28, v29
    v_cvt_pk_bf16_f32 v123, v30, v31
    s_add_u32 m0, s47, 8192
    s_add_u32 s42, s48, 8192
    buffer_load_dwordx4 v4, s[16:19], s42 offen lds
    v_exp_f32 v32, v32
    v_exp_f32 v33, v33
    v_exp_f32 v34, v34
    s_waitcnt lgkmcnt(2)
    v_mfma_f32_32x32x16_bf16 v[88:103], v[140:143], v[120:123], v[88:103]
    v_exp_f32 v35, v35
    v_exp_f32 v36, v36
    v_exp_f32 v37, v37
    v_exp_f32 v38, v38
    v_exp_f32 v39, v39
    v_cvt_pk_bf16_f32 v124, v32, v33
    v_cvt_pk_bf16_f32 v125, v34, v35
    v_cvt_pk_bf16_f32 v126, v36, v37
    v_cvt_pk_bf16_f32 v127, v38, v39
    s_waitcnt lgkmcnt(0)
    v_exp_f32 v40, v40
    v_exp_f32 v41, v41
    v_mfma_f32_32x32x16_bf16 v[24:39], v[136:139], v[10:13], v[56:71]
    v_exp_f32 v42, v42
    v_exp_f32 v43, v43
    v_exp_f32 v44, v44
    v_mfma_f32_32x32x16_bf16 v[88:103], v[144:147], v[124:127], v[88:103]
    v_exp_f32 v45, v45
    v_exp_f32 v46, v46
    v_exp_f32 v47, v47
    v_cvt_pk_bf16_f32 v128, v40, v41
    v_cvt_pk_bf16_f32 v129, v42, v43
    v_cvt_pk_bf16_f32 v130, v44, v45
    v_cvt_pk_bf16_f32 v131, v46, v47
    v_exp_f32 v48, v48
    v_exp_f32 v49, v49
    v_exp_f32 v50, v50
    v_mfma_f32_32x32x16_bf16 v[104:119], v[140:143], v[128:131], v[104:119]
    ds_read_b128 v[140:143], v19 offset:1024
    v_exp_f32 v51, v51
    v_exp_f32 v52, v52
    v_exp_f32 v53, v53
    v_exp_f32 v54, v54
    v_exp_f32 v55, v55
    v_cvt_pk_bf16_f32 v132, v48, v49
    v_cvt_pk_bf16_f32 v133, v50, v51
    v_cvt_pk_bf16_f32 v134, v52, v53
    v_cvt_pk_bf16_f32 v135, v54, v55
    s_waitcnt vmcnt(3)
    s_barrier
    s_setprio 1
    v_mfma_f32_32x32x16_bf16 v[40:55], v[136:139], v[14:17], v[72:87]
    v_exp_f32 v24, v24
    v_exp_f32 v25, v25
    v_exp_f32 v26, v26
    v_mfma_f32_32x32x16_bf16 v[104:119], v[144:147], v[132:135], v[104:119]
    ds_read_b128 v[144:147], v19 offset:1536
    ds_read_b128 v[136:139], v18 offset:2048
    v_exp_f32 v27, v27
    v_exp_f32 v28, v28
    v_exp_f32 v29, v29
    v_exp_f32 v30, v30
    v_exp_f32 v31, v31
    v_cvt_pk_bf16_f32 v120, v24, v25
    v_cvt_pk_bf16_f32 v121, v26, v27
    v_cvt_pk_bf16_f32 v122, v28, v29
    v_cvt_pk_bf16_f32 v123, v30, v31
    s_add_u32 m0, s47, 10240
    s_add_u32 s42, s48, 10240
    buffer_load_dwordx4 v4, s[16:19], s42 offen lds
    v_exp_f32 v32, v32
    v_exp_f32 v33, v33
    v_exp_f32 v34, v34
    s_waitcnt lgkmcnt(2)
    v_mfma_f32_32x32x16_bf16 v[88:103], v[140:143], v[120:123], v[88:103]
    v_exp_f32 v35, v35
    v_exp_f32 v36, v36
    v_exp_f32 v37, v37
    v_exp_f32 v38, v38
    v_exp_f32 v39, v39
    v_cvt_pk_bf16_f32 v124, v32, v33
    v_cvt_pk_bf16_f32 v125, v34, v35
    v_cvt_pk_bf16_f32 v126, v36, v37
    v_cvt_pk_bf16_f32 v127, v38, v39
    s_waitcnt lgkmcnt(0)
    v_exp_f32 v40, v40
    v_exp_f32 v41, v41
    v_mfma_f32_32x32x16_bf16 v[24:39], v[136:139], v[10:13], v[56:71]
    v_exp_f32 v42, v42
    v_exp_f32 v43, v43
    v_exp_f32 v44, v44
    v_mfma_f32_32x32x16_bf16 v[88:103], v[144:147], v[124:127], v[88:103]
    v_exp_f32 v45, v45
    v_exp_f32 v46, v46
    v_exp_f32 v47, v47
    v_cvt_pk_bf16_f32 v128, v40, v41
    v_cvt_pk_bf16_f32 v129, v42, v43
    v_cvt_pk_bf16_f32 v130, v44, v45
    v_cvt_pk_bf16_f32 v131, v46, v47
    v_exp_f32 v48, v48
    v_exp_f32 v49, v49
    v_exp_f32 v50, v50
    v_mfma_f32_32x32x16_bf16 v[104:119], v[140:143], v[128:131], v[104:119]
    ds_read_b128 v[140:143], v19 offset:2048
    v_exp_f32 v51, v51
    v_exp_f32 v52, v52
    v_exp_f32 v53, v53
    v_exp_f32 v54, v54
    v_exp_f32 v55, v55
    v_cvt_pk_bf16_f32 v132, v48, v49
    v_cvt_pk_bf16_f32 v133, v50, v51
    v_cvt_pk_bf16_f32 v134, v52, v53
    v_cvt_pk_bf16_f32 v135, v54, v55
    s_setprio 0
    v_mfma_f32_32x32x16_bf16 v[40:55], v[136:139], v[14:17], v[72:87]
    v_exp_f32 v24, v24
    v_exp_f32 v25, v25
    v_exp_f32 v26, v26
    v_mfma_f32_32x32x16_bf16 v[104:119], v[144:147], v[132:135], v[104:119]
    ds_read_b128 v[144:147], v19 offset:2560
    ds_read_b128 v[136:139], v18 offset:3072
    v_exp_f32 v27, v27
    v_exp_f32 v28, v28
    v_exp_f32 v29, v29
    v_exp_f32 v30, v30
    v_exp_f32 v31, v31
    v_cvt_pk_bf16_f32 v120, v24, v25
    v_cvt_pk_bf16_f32 v121, v26, v27
    v_cvt_pk_bf16_f32 v122, v28, v29
    v_cvt_pk_bf16_f32 v123, v30, v31
    s_add_u32 m0, s47, 12288
    s_add_u32 s42, s48, 12288
    buffer_load_dwordx4 v4, s[16:19], s42 offen lds
    v_exp_f32 v32, v32
    v_exp_f32 v33, v33
    v_exp_f32 v34, v34
    s_waitcnt lgkmcnt(2)
    v_mfma_f32_32x32x16_bf16 v[88:103], v[140:143], v[120:123], v[88:103]
    v_exp_f32 v35, v35
    v_exp_f32 v36, v36
    v_exp_f32 v37, v37
    v_exp_f32 v38, v38
    v_exp_f32 v39, v39
    v_cvt_pk_bf16_f32 v124, v32, v33
    v_cvt_pk_bf16_f32 v125, v34, v35
    v_cvt_pk_bf16_f32 v126, v36, v37
    v_cvt_pk_bf16_f32 v127, v38, v39
    s_waitcnt lgkmcnt(0)
    v_exp_f32 v40, v40
    v_exp_f32 v41, v41
    v_mfma_f32_32x32x16_bf16 v[24:39], v[136:139], v[10:13], v[56:71]
    v_exp_f32 v42, v42
    v_exp_f32 v43, v43
    v_exp_f32 v44, v44
    v_mfma_f32_32x32x16_bf16 v[88:103], v[144:147], v[124:127], v[88:103]
    v_exp_f32 v45, v45
    v_exp_f32 v46, v46
    v_exp_f32 v47, v47
    v_cvt_pk_bf16_f32 v128, v40, v41
    v_cvt_pk_bf16_f32 v129, v42, v43
    v_cvt_pk_bf16_f32 v130, v44, v45
    v_cvt_pk_bf16_f32 v131, v46, v47
    s_cmp_lg_u32 s36, 0
    s_cbranch_scc1 block_kernel_xt1
    v_mov_b32 v6, 0
    v_mov_b32 v21, s41
    s_lshl_b32 s42, s40, 2
    s_mov_b64 exec, 1
    buffer_store_dword v21, v6, s[28:31], s42 offen sc1
    s_mov_b64 exec, -1
block_kernel_xt1:
    v_exp_f32 v48, v48
    v_exp_f32 v49, v49
    v_exp_f32 v50, v50
    v_mfma_f32_32x32x16_bf16 v[104:119], v[140:143], v[128:131], v[104:119]
    ds_read_b128 v[140:143], v19 offset:3072
    v_exp_f32 v51, v51
    v_exp_f32 v52, v52
    v_exp_f32 v53, v53
    v_exp_f32 v54, v54
    v_exp_f32 v55, v55
    v_cvt_pk_bf16_f32 v132, v48, v49
    v_cvt_pk_bf16_f32 v133, v50, v51
    v_cvt_pk_bf16_f32 v134, v52, v53
    v_cvt_pk_bf16_f32 v135, v54, v55
    s_waitcnt vmcnt(3)
    s_barrier
    s_setprio 3
    v_mfma_f32_32x32x16_bf16 v[40:55], v[136:139], v[14:17], v[72:87]
    v_exp_f32 v24, v24
    v_exp_f32 v25, v25
    v_exp_f32 v26, v26
    v_mfma_f32_32x32x16_bf16 v[104:119], v[144:147], v[132:135], v[104:119]
    ds_read_b128 v[144:147], v19 offset:3584
    ds_read_b128 v[136:139], v18 offset:4096
    v_exp_f32 v27, v27
    v_exp_f32 v28, v28
    v_exp_f32 v29, v29
    v_exp_f32 v30, v30
    v_exp_f32 v31, v31
    v_cvt_pk_bf16_f32 v120, v24, v25
    v_cvt_pk_bf16_f32 v121, v26, v27
    v_cvt_pk_bf16_f32 v122, v28, v29
    v_cvt_pk_bf16_f32 v123, v30, v31
    s_add_u32 m0, s47, 14336
    s_add_u32 s42, s48, 14336
    buffer_load_dwordx4 v4, s[16:19], s42 offen lds
    v_exp_f32 v32, v32
    v_exp_f32 v33, v33
    v_exp_f32 v34, v34
    s_waitcnt lgkmcnt(2)
    v_mfma_f32_32x32x16_bf16 v[88:103], v[140:143], v[120:123], v[88:103]
    v_exp_f32 v35, v35
    v_exp_f32 v36, v36
    v_exp_f32 v37, v37
    v_exp_f32 v38, v38
    v_exp_f32 v39, v39
    v_cvt_pk_bf16_f32 v124, v32, v33
    v_cvt_pk_bf16_f32 v125, v34, v35
    v_cvt_pk_bf16_f32 v126, v36, v37
    v_cvt_pk_bf16_f32 v127, v38, v39
    s_waitcnt lgkmcnt(0)
    v_exp_f32 v40, v40
    v_exp_f32 v41, v41
    v_mfma_f32_32x32x16_bf16 v[24:39], v[136:139], v[10:13], v[56:71]
    v_exp_f32 v42, v42
    v_exp_f32 v43, v43
    v_exp_f32 v44, v44
    v_mfma_f32_32x32x16_bf16 v[88:103], v[144:147], v[124:127], v[88:103]
    v_exp_f32 v45, v45
    v_exp_f32 v46, v46
    v_exp_f32 v47, v47
    v_cvt_pk_bf16_f32 v128, v40, v41
    v_cvt_pk_bf16_f32 v129, v42, v43
    v_cvt_pk_bf16_f32 v130, v44, v45
    v_cvt_pk_bf16_f32 v131, v46, v47
    s_lshr_b32 s49, s40, 3
    s_lshl_b32 s43, s39, 2
    s_add_u32 s49, s49, s43
    s_and_b32 s45, s40, 7
    s_lshl_b32 s42, s49, 13
    s_lshl_b32 s43, s45, 9
    s_add_u32 s42, s42, s43
    s_add_u32 s42, s42, 17825792
    s_lshl_b32 s49, s49, 16
    s_lshl_b32 s45, s45, 12
    s_add_u32 s49, s49, s45
    s_add_u32 s49, s49, 8388608
    s_cmp_eq_u32 s36, 4
    s_cselect_b32 s42, s49, s42
    s_cselect_b32 s45, 31, 3
    s_cselect_b32 s44, 15, 12
    s_mov_b32 s43, 5
    s_lshl_b32 s49, s39, 8
    s_add_u32 s49, s49, s40
    s_lshl_b32 s49, s49, 10
    s_add_u32 s49, s49, 6291456
    s_cmp_eq_u32 s36, 5
    s_cselect_b32 s42, s49, s42
    s_cselect_b32 s45, 7, s45
    s_cselect_b32 s44, 15, s44
    s_cselect_b32 s43, 3, s43
    v_lshrrev_b32 v6, s43, v1
    v_lshlrev_b32 v6, s44, v6
    s_cmp_ge_u32 s40, 14
    s_cselect_b32 s43, 4, 0
    s_cselect_b32 s44, 14, 0
    s_lshl_b32 s49, s39, 3
    s_add_u32 s49, s49, s43
    s_add_u32 s49, s49, s37
    s_mul_i32 s49, s49, 114688
    s_sub_u32 s44, s40, s44
    s_min_u32 s44, s44, 13
    s_lshl_b32 s44, s44, 13
    s_add_u32 s49, s49, s44
    s_add_u32 s49, s49, 10485760
    s_cmp_eq_u32 s38, 0
    s_cselect_b32 s42, s49, s42
    s_cselect_b32 s45, 63, s45
    s_cselect_b32 s44, 0, -1
    v_and_b32 v6, s44, v6
    v_and_b32 v21, s45, v1
    v_lshl_add_u32 v6, v21, 7, v6
    v_add_u32 v21, s42, v6
    v_lshlrev_b32 v6, 7, v1
    v_exp_f32 v48, v48
    v_exp_f32 v49, v49
    v_exp_f32 v50, v50
    v_mfma_f32_32x32x16_bf16 v[104:119], v[140:143], v[128:131], v[104:119]
    v_add_u32 v19, v19, v20
    ds_read_b128 v[140:143], v19
    v_exp_f32 v51, v51
    v_exp_f32 v52, v52
    v_exp_f32 v53, v53
    v_exp_f32 v54, v54
    v_exp_f32 v55, v55
    v_cvt_pk_bf16_f32 v132, v48, v49
    v_cvt_pk_bf16_f32 v133, v50, v51
    v_cvt_pk_bf16_f32 v134, v52, v53
    v_cvt_pk_bf16_f32 v135, v54, v55
    s_setprio 2
    v_mfma_f32_32x32x16_bf16 v[40:55], v[136:139], v[14:17], v[72:87]
    v_exp_f32 v24, v24
    v_exp_f32 v25, v25
    v_exp_f32 v26, v26
    v_mfma_f32_32x32x16_bf16 v[104:119], v[144:147], v[132:135], v[104:119]
    ds_read_b128 v[144:147], v19 offset:512
    ds_read_b128 v[136:139], v18 offset:5120
    v_exp_f32 v27, v27
    v_exp_f32 v28, v28
    v_exp_f32 v29, v29
    v_exp_f32 v30, v30
    v_exp_f32 v31, v31
    v_cvt_pk_bf16_f32 v120, v24, v25
    v_cvt_pk_bf16_f32 v121, v26, v27
    v_cvt_pk_bf16_f32 v122, v28, v29
    v_cvt_pk_bf16_f32 v123, v30, v31
    s_add_u32 m0, s47, 16384
    s_add_u32 s42, s48, 16384
    buffer_load_dwordx4 v4, s[16:19], s42 offen lds
    v_exp_f32 v32, v32
    v_exp_f32 v33, v33
    v_exp_f32 v34, v34
    s_waitcnt lgkmcnt(2)
    v_mfma_f32_32x32x16_bf16 v[88:103], v[140:143], v[120:123], v[88:103]
    v_exp_f32 v35, v35
    v_exp_f32 v36, v36
    v_exp_f32 v37, v37
    v_exp_f32 v38, v38
    v_exp_f32 v39, v39
    v_cvt_pk_bf16_f32 v124, v32, v33
    v_cvt_pk_bf16_f32 v125, v34, v35
    v_cvt_pk_bf16_f32 v126, v36, v37
    v_cvt_pk_bf16_f32 v127, v38, v39
    s_waitcnt lgkmcnt(0)
    v_exp_f32 v40, v40
    v_exp_f32 v41, v41
    v_mfma_f32_32x32x16_bf16 v[24:39], v[136:139], v[10:13], v[56:71]
    v_exp_f32 v42, v42
    v_exp_f32 v43, v43
    v_exp_f32 v44, v44
    v_mfma_f32_32x32x16_bf16 v[88:103], v[144:147], v[124:127], v[88:103]
    v_exp_f32 v45, v45
    v_exp_f32 v46, v46
    v_exp_f32 v47, v47
    v_cvt_pk_bf16_f32 v128, v40, v41
    v_cvt_pk_bf16_f32 v129, v42, v43
    v_cvt_pk_bf16_f32 v130, v44, v45
    v_cvt_pk_bf16_f32 v131, v46, v47
    v_exp_f32 v48, v48
    v_exp_f32 v49, v49
    v_exp_f32 v50, v50
    v_mfma_f32_32x32x16_bf16 v[104:119], v[140:143], v[128:131], v[104:119]
    ds_read_b128 v[140:143], v19 offset:1024
    v_exp_f32 v51, v51
    v_exp_f32 v52, v52
    v_exp_f32 v53, v53
    v_exp_f32 v54, v54
    v_exp_f32 v55, v55
    v_cvt_pk_bf16_f32 v132, v48, v49
    v_cvt_pk_bf16_f32 v133, v50, v51
    v_cvt_pk_bf16_f32 v134, v52, v53
    v_cvt_pk_bf16_f32 v135, v54, v55
    s_setprio 1
    v_mfma_f32_32x32x16_bf16 v[40:55], v[136:139], v[14:17], v[72:87]
    v_exp_f32 v24, v24
    v_exp_f32 v25, v25
    v_exp_f32 v26, v26
    v_mfma_f32_32x32x16_bf16 v[104:119], v[144:147], v[132:135], v[104:119]
    ds_read_b128 v[144:147], v19 offset:1536
    ds_read_b128 v[136:139], v18 offset:6144
    v_exp_f32 v27, v27
    v_exp_f32 v28, v28
    v_exp_f32 v29, v29
    v_exp_f32 v30, v30
    v_exp_f32 v31, v31
    v_cvt_pk_bf16_f32 v120, v24, v25
    v_cvt_pk_bf16_f32 v121, v26, v27
    v_cvt_pk_bf16_f32 v122, v28, v29
    v_cvt_pk_bf16_f32 v123, v30, v31
    s_add_u32 m0, s47, 18432
    s_add_u32 s42, s48, 18432
    buffer_load_dwordx4 v4, s[16:19], s42 offen lds
    v_exp_f32 v32, v32
    v_exp_f32 v33, v33
    v_exp_f32 v34, v34
    s_waitcnt lgkmcnt(2)
    v_mfma_f32_32x32x16_bf16 v[88:103], v[140:143], v[120:123], v[88:103]
    v_exp_f32 v35, v35
    v_exp_f32 v36, v36
    v_exp_f32 v37, v37
    v_exp_f32 v38, v38
    v_exp_f32 v39, v39
    v_cvt_pk_bf16_f32 v124, v32, v33
    v_cvt_pk_bf16_f32 v125, v34, v35
    v_cvt_pk_bf16_f32 v126, v36, v37
    v_cvt_pk_bf16_f32 v127, v38, v39
    s_waitcnt lgkmcnt(0)
    v_exp_f32 v40, v40
    v_exp_f32 v41, v41
    v_mfma_f32_32x32x16_bf16 v[24:39], v[136:139], v[10:13], v[56:71]
    v_exp_f32 v42, v42
    v_exp_f32 v43, v43
    v_exp_f32 v44, v44
    v_mfma_f32_32x32x16_bf16 v[88:103], v[144:147], v[124:127], v[88:103]
    v_exp_f32 v45, v45
    v_exp_f32 v46, v46
    v_exp_f32 v47, v47
    v_cvt_pk_bf16_f32 v128, v40, v41
    v_cvt_pk_bf16_f32 v129, v42, v43
    v_cvt_pk_bf16_f32 v130, v44, v45
    v_cvt_pk_bf16_f32 v131, v46, v47
    v_exp_f32 v48, v48
    v_exp_f32 v49, v49
    v_exp_f32 v50, v50
    v_mfma_f32_32x32x16_bf16 v[104:119], v[140:143], v[128:131], v[104:119]
    ds_read_b128 v[140:143], v19 offset:2048
    v_exp_f32 v51, v51
    v_exp_f32 v52, v52
    v_exp_f32 v53, v53
    v_exp_f32 v54, v54
    v_exp_f32 v55, v55
    v_cvt_pk_bf16_f32 v132, v48, v49
    v_cvt_pk_bf16_f32 v133, v50, v51
    v_cvt_pk_bf16_f32 v134, v52, v53
    v_cvt_pk_bf16_f32 v135, v54, v55
    s_setprio 0
    v_mfma_f32_32x32x16_bf16 v[40:55], v[136:139], v[14:17], v[72:87]
    v_exp_f32 v24, v24
    v_exp_f32 v25, v25
    v_exp_f32 v26, v26
    v_mfma_f32_32x32x16_bf16 v[104:119], v[144:147], v[132:135], v[104:119]
    ds_read_b128 v[144:147], v19 offset:2560
    ds_read_b128 v[136:139], v18 offset:7168
    v_exp_f32 v27, v27
    v_exp_f32 v28, v28
    v_exp_f32 v29, v29
    v_exp_f32 v30, v30
    v_exp_f32 v31, v31
    v_cvt_pk_bf16_f32 v120, v24, v25
    v_cvt_pk_bf16_f32 v121, v26, v27
    v_cvt_pk_bf16_f32 v122, v28, v29
    v_cvt_pk_bf16_f32 v123, v30, v31
    s_add_u32 m0, s47, 20480
    s_add_u32 s42, s48, 20480
    buffer_load_dwordx4 v4, s[16:19], s42 offen lds
    v_exp_f32 v32, v32
    v_exp_f32 v33, v33
    v_exp_f32 v34, v34
    s_waitcnt lgkmcnt(2)
    v_mfma_f32_32x32x16_bf16 v[88:103], v[140:143], v[120:123], v[88:103]
    v_exp_f32 v35, v35
    v_exp_f32 v36, v36
    v_exp_f32 v37, v37
    v_exp_f32 v38, v38
    v_exp_f32 v39, v39
    v_cvt_pk_bf16_f32 v124, v32, v33
    v_cvt_pk_bf16_f32 v125, v34, v35
    v_cvt_pk_bf16_f32 v126, v36, v37
    v_cvt_pk_bf16_f32 v127, v38, v39
    s_waitcnt lgkmcnt(0)
    v_exp_f32 v40, v40
    v_exp_f32 v41, v41
    v_mfma_f32_32x32x16_bf16 v[24:39], v[136:139], v[10:13], v[56:71]
    v_exp_f32 v42, v42
    v_exp_f32 v43, v43
    v_exp_f32 v44, v44
    v_mfma_f32_32x32x16_bf16 v[88:103], v[144:147], v[124:127], v[88:103]
    v_exp_f32 v45, v45
    v_exp_f32 v46, v46
    v_exp_f32 v47, v47
    v_cvt_pk_bf16_f32 v128, v40, v41
    v_cvt_pk_bf16_f32 v129, v42, v43
    v_cvt_pk_bf16_f32 v130, v44, v45
    v_cvt_pk_bf16_f32 v131, v46, v47
    v_exp_f32 v48, v48
    v_exp_f32 v49, v49
    v_exp_f32 v50, v50
    v_mfma_f32_32x32x16_bf16 v[104:119], v[140:143], v[128:131], v[104:119]
    ds_read_b128 v[140:143], v19 offset:3072
    v_exp_f32 v51, v51
    v_exp_f32 v52, v52
    v_exp_f32 v53, v53
    v_exp_f32 v54, v54
    v_exp_f32 v55, v55
    v_cvt_pk_bf16_f32 v132, v48, v49
    v_cvt_pk_bf16_f32 v133, v50, v51
    v_cvt_pk_bf16_f32 v134, v52, v53
    v_cvt_pk_bf16_f32 v135, v54, v55
    s_waitcnt vmcnt(5)
    s_barrier
    s_setprio 3
    v_mfma_f32_32x32x16_bf16 v[40:55], v[136:139], v[14:17], v[72:87]
    v_exp_f32 v24, v24
    v_exp_f32 v25, v25
    v_exp_f32 v26, v26
    v_mfma_f32_32x32x16_bf16 v[104:119], v[144:147], v[132:135], v[104:119]
    ds_read_b128 v[144:147], v19 offset:3584
    ds_read_b128 v[136:139], v18 offset:8192
    v_exp_f32 v27, v27
    v_exp_f32 v28, v28
    v_exp_f32 v29, v29
    v_exp_f32 v30, v30
    v_exp_f32 v31, v31
    v_cvt_pk_bf16_f32 v120, v24, v25
    v_cvt_pk_bf16_f32 v121, v26, v27
    v_cvt_pk_bf16_f32 v122, v28, v29
    v_cvt_pk_bf16_f32 v123, v30, v31
    s_add_u32 m0, s47, 22528
    s_add_u32 s42, s48, 22528
    buffer_load_dwordx4 v4, s[16:19], s42 offen lds
    v_exp_f32 v32, v32
    v_exp_f32 v33, v33
    v_exp_f32 v34, v34
    s_waitcnt lgkmcnt(2)
    v_mfma_f32_32x32x16_bf16 v[88:103], v[140:143], v[120:123], v[88:103]
    v_exp_f32 v35, v35
    v_exp_f32 v36, v36
    v_exp_f32 v37, v37
    v_exp_f32 v38, v38
    v_exp_f32 v39, v39
    v_cvt_pk_bf16_f32 v124, v32, v33
    v_cvt_pk_bf16_f32 v125, v34, v35
    v_cvt_pk_bf16_f32 v126, v36, v37
    v_cvt_pk_bf16_f32 v127, v38, v39
    s_waitcnt lgkmcnt(0)
    v_exp_f32 v40, v40
    v_exp_f32 v41, v41
    v_mfma_f32_32x32x16_bf16 v[24:39], v[136:139], v[10:13], v[56:71]
    v_exp_f32 v42, v42
    v_exp_f32 v43, v43
    v_exp_f32 v44, v44
    v_mfma_f32_32x32x16_bf16 v[88:103], v[144:147], v[124:127], v[88:103]
    v_exp_f32 v45, v45
    v_exp_f32 v46, v46
    v_exp_f32 v47, v47
    v_cvt_pk_bf16_f32 v128, v40, v41
    v_cvt_pk_bf16_f32 v129, v42, v43
    v_cvt_pk_bf16_f32 v130, v44, v45
    v_cvt_pk_bf16_f32 v131, v46, v47
    v_exp_f32 v48, v48
    v_exp_f32 v49, v49
    v_exp_f32 v50, v50
    v_mfma_f32_32x32x16_bf16 v[104:119], v[140:143], v[128:131], v[104:119]
    v_add_u32 v19, v19, v20
    ds_read_b128 v[140:143], v19
    v_exp_f32 v51, v51
    v_exp_f32 v52, v52
    v_exp_f32 v53, v53
    v_exp_f32 v54, v54
    v_exp_f32 v55, v55
    v_cvt_pk_bf16_f32 v132, v48, v49
    v_cvt_pk_bf16_f32 v133, v50, v51
    v_cvt_pk_bf16_f32 v134, v52, v53
    v_cvt_pk_bf16_f32 v135, v54, v55
    s_setprio 2
    v_mfma_f32_32x32x16_bf16 v[40:55], v[136:139], v[14:17], v[72:87]
    v_exp_f32 v24, v24
    v_exp_f32 v25, v25
    v_exp_f32 v26, v26
    v_mfma_f32_32x32x16_bf16 v[104:119], v[144:147], v[132:135], v[104:119]
    ds_read_b128 v[144:147], v19 offset:512
    ds_read_b128 v[136:139], v18 offset:9216
    v_exp_f32 v27, v27
    v_exp_f32 v28, v28
    v_exp_f32 v29, v29
    v_exp_f32 v30, v30
    v_exp_f32 v31, v31
    v_cvt_pk_bf16_f32 v120, v24, v25
    v_cvt_pk_bf16_f32 v121, v26, v27
    v_cvt_pk_bf16_f32 v122, v28, v29
    v_cvt_pk_bf16_f32 v123, v30, v31
    s_add_u32 m0, s47, 24576
    s_add_u32 s42, s48, 24576
    buffer_load_dwordx4 v4, s[16:19], s42 offen lds
    v_exp_f32 v32, v32
    v_exp_f32 v33, v33
    v_exp_f32 v34, v34
    s_waitcnt lgkmcnt(2)
    v_mfma_f32_32x32x16_bf16 v[88:103], v[140:143], v[120:123], v[88:103]
    v_exp_f32 v35, v35
    v_exp_f32 v36, v36
    v_exp_f32 v37, v37
    v_exp_f32 v38, v38
    v_exp_f32 v39, v39
    v_cvt_pk_bf16_f32 v124, v32, v33
    v_cvt_pk_bf16_f32 v125, v34, v35
    v_cvt_pk_bf16_f32 v126, v36, v37
    v_cvt_pk_bf16_f32 v127, v38, v39
    s_waitcnt lgkmcnt(0)
    v_exp_f32 v40, v40
    v_exp_f32 v41, v41
    v_mfma_f32_32x32x16_bf16 v[24:39], v[136:139], v[10:13], v[56:71]
    v_exp_f32 v42, v42
    v_exp_f32 v43, v43
    v_exp_f32 v44, v44
    v_mfma_f32_32x32x16_bf16 v[88:103], v[144:147], v[124:127], v[88:103]
    v_exp_f32 v45, v45
    v_exp_f32 v46, v46
    v_exp_f32 v47, v47
    v_cvt_pk_bf16_f32 v128, v40, v41
    v_cvt_pk_bf16_f32 v129, v42, v43
    v_cvt_pk_bf16_f32 v130, v44, v45
    v_cvt_pk_bf16_f32 v131, v46, v47
    s_add_u32 s42, s32, 0
    buffer_load_dwordx4 a[8:11], v8, s[20:23], s42 offen
    s_add_u32 s42, s32, 8192
    buffer_load_dwordx4 a[12:15], v8, s[20:23], s42 offen
    v_exp_f32 v48, v48
    v_exp_f32 v49, v49
    v_exp_f32 v50, v50
    v_mfma_f32_32x32x16_bf16 v[104:119], v[140:143], v[128:131], v[104:119]
    ds_read_b128 v[140:143], v19 offset:1024
    v_exp_f32 v51, v51
    v_exp_f32 v52, v52
    v_exp_f32 v53, v53
    v_exp_f32 v54, v54
    v_exp_f32 v55, v55
    v_cvt_pk_bf16_f32 v132, v48, v49
    v_cvt_pk_bf16_f32 v133, v50, v51
    v_cvt_pk_bf16_f32 v134, v52, v53
    v_cvt_pk_bf16_f32 v135, v54, v55
    s_setprio 1
    v_mfma_f32_32x32x16_bf16 v[40:55], v[136:139], v[14:17], v[72:87]
    v_exp_f32 v24, v24
    v_exp_f32 v25, v25
    v_exp_f32 v26, v26
    v_mfma_f32_32x32x16_bf16 v[104:119], v[144:147], v[132:135], v[104:119]
    ds_read_b128 v[144:147], v19 offset:1536
    ds_read_b128 v[136:139], v18 offset:10240
    v_exp_f32 v27, v27
    v_exp_f32 v28, v28
    v_exp_f32 v29, v29
    v_exp_f32 v30, v30
    v_exp_f32 v31, v31
    v_cvt_pk_bf16_f32 v120, v24, v25
    v_cvt_pk_bf16_f32 v121, v26, v27
    v_cvt_pk_bf16_f32 v122, v28, v29
    v_cvt_pk_bf16_f32 v123, v30, v31
    s_add_u32 m0, s47, 26624
    s_add_u32 s42, s48, 26624
    buffer_load_dwordx4 v4, s[16:19], s42 offen lds
    v_exp_f32 v32, v32
    v_exp_f32 v33, v33
    v_exp_f32 v34, v34
    s_waitcnt lgkmcnt(2)
    v_mfma_f32_32x32x16_bf16 v[88:103], v[140:143], v[120:123], v[88:103]
    v_exp_f32 v35, v35
    v_exp_f32 v36, v36
    v_exp_f32 v37, v37
    v_exp_f32 v38, v38
    v_exp_f32 v39, v39
    v_cvt_pk_bf16_f32 v124, v32, v33
    v_cvt_pk_bf16_f32 v125, v34, v35
    v_cvt_pk_bf16_f32 v126, v36, v37
    v_cvt_pk_bf16_f32 v127, v38, v39
    s_waitcnt lgkmcnt(0)
    v_exp_f32 v40, v40
    v_exp_f32 v41, v41
    v_mfma_f32_32x32x16_bf16 v[24:39], v[136:139], v[10:13], v[56:71]
    v_exp_f32 v42, v42
    v_exp_f32 v43, v43
    v_exp_f32 v44, v44
    v_mfma_f32_32x32x16_bf16 v[88:103], v[144:147], v[124:127], v[88:103]
    v_exp_f32 v45, v45
    v_exp_f32 v46, v46
    v_exp_f32 v47, v47
    v_cvt_pk_bf16_f32 v128, v40, v41
    v_cvt_pk_bf16_f32 v129, v42, v43
    v_cvt_pk_bf16_f32 v130, v44, v45
    v_cvt_pk_bf16_f32 v131, v46, v47
    s_add_u32 s42, s32, 16384
    buffer_load_dwordx4 a[16:19], v8, s[20:23], s42 offen
    s_add_u32 s42, s32, 24576
    buffer_load_dwordx4 a[20:23], v8, s[20:23], s42 offen
    v_exp_f32 v48, v48
    v_exp_f32 v49, v49
    v_exp_f32 v50, v50
    v_mfma_f32_32x32x16_bf16 v[104:119], v[140:143], v[128:131], v[104:119]
    ds_read_b128 v[140:143], v19 offset:2048
    v_exp_f32 v51, v51
    v_exp_f32 v52, v52
    v_exp_f32 v53, v53
    v_exp_f32 v54, v54
    v_exp_f32 v55, v55
    v_cvt_pk_bf16_f32 v132, v48, v49
    v_cvt_pk_bf16_f32 v133, v50, v51
    v_cvt_pk_bf16_f32 v134, v52, v53
    v_cvt_pk_bf16_f32 v135, v54, v55
    s_setprio 0
    v_mfma_f32_32x32x16_bf16 v[40:55], v[136:139], v[14:17], v[72:87]
    v_exp_f32 v24, v24
    v_exp_f32 v25, v25
    v_exp_f32 v26, v26
    v_mfma_f32_32x32x16_bf16 v[104:119], v[144:147], v[132:135], v[104:119]
    ds_read_b128 v[144:147], v19 offset:2560
    ds_read_b128 v[136:139], v18 offset:11264
    v_exp_f32 v27, v27
    v_exp_f32 v28, v28
    v_exp_f32 v29, v29
    v_exp_f32 v30, v30
    v_exp_f32 v31, v31
    v_cvt_pk_bf16_f32 v120, v24, v25
    v_cvt_pk_bf16_f32 v121, v26, v27
    v_cvt_pk_bf16_f32 v122, v28, v29
    v_cvt_pk_bf16_f32 v123, v30, v31
    s_add_u32 m0, s47, 28672
    s_add_u32 s42, s48, 28672
    buffer_load_dwordx4 v4, s[16:19], s42 offen lds
    v_exp_f32 v32, v32
    v_exp_f32 v33, v33
    v_exp_f32 v34, v34
    s_waitcnt lgkmcnt(2)
    v_mfma_f32_32x32x16_bf16 v[88:103], v[140:143], v[120:123], v[88:103]
    v_exp_f32 v35, v35
    v_exp_f32 v36, v36
    v_exp_f32 v37, v37
    v_exp_f32 v38, v38
    v_exp_f32 v39, v39
    v_cvt_pk_bf16_f32 v124, v32, v33
    v_cvt_pk_bf16_f32 v125, v34, v35
    v_cvt_pk_bf16_f32 v126, v36, v37
    v_cvt_pk_bf16_f32 v127, v38, v39
    s_waitcnt lgkmcnt(0)
    v_exp_f32 v40, v40
    v_exp_f32 v41, v41
    v_mfma_f32_32x32x16_bf16 v[24:39], v[136:139], v[10:13], v[56:71]
    v_exp_f32 v42, v42
    v_exp_f32 v43, v43
    v_exp_f32 v44, v44
    v_mfma_f32_32x32x16_bf16 v[88:103], v[144:147], v[124:127], v[88:103]
    v_exp_f32 v45, v45
    v_exp_f32 v46, v46
    v_exp_f32 v47, v47
    v_cvt_pk_bf16_f32 v128, v40, v41
    v_cvt_pk_bf16_f32 v129, v42, v43
    v_cvt_pk_bf16_f32 v130, v44, v45
    v_cvt_pk_bf16_f32 v131, v46, v47
    s_add_u32 s42, s32, 131072
    buffer_load_dwordx4 a[24:27], v8, s[20:23], s42 offen
    s_add_u32 s42, s32, 139264
    buffer_load_dwordx4 a[28:31], v8, s[20:23], s42 offen
    v_exp_f32 v48, v48
    v_exp_f32 v49, v49
    v_exp_f32 v50, v50
    v_mfma_f32_32x32x16_bf16 v[104:119], v[140:143], v[128:131], v[104:119]
    ds_read_b128 v[140:143], v19 offset:3072
    v_exp_f32 v51, v51
    v_exp_f32 v52, v52
    v_exp_f32 v53, v53
    v_exp_f32 v54, v54
    v_exp_f32 v55, v55
    v_cvt_pk_bf16_f32 v132, v48, v49
    v_cvt_pk_bf16_f32 v133, v50, v51
    v_cvt_pk_bf16_f32 v134, v52, v53
    v_cvt_pk_bf16_f32 v135, v54, v55
    s_waitcnt vmcnt(13)
    s_barrier
    s_setprio 3
    v_mfma_f32_32x32x16_bf16 v[40:55], v[136:139], v[14:17], v[72:87]
    v_exp_f32 v24, v24
    v_exp_f32 v25, v25
    v_exp_f32 v26, v26
    v_mfma_f32_32x32x16_bf16 v[104:119], v[144:147], v[132:135], v[104:119]
    ds_read_b128 v[144:147], v19 offset:3584
    ds_read_b128 v[136:139], v18 offset:12288
    v_exp_f32 v27, v27
    v_exp_f32 v28, v28
    v_exp_f32 v29, v29
    v_exp_f32 v30, v30
    v_exp_f32 v31, v31
    v_cvt_pk_bf16_f32 v120, v24, v25
    v_cvt_pk_bf16_f32 v121, v26, v27
    v_cvt_pk_bf16_f32 v122, v28, v29
    v_cvt_pk_bf16_f32 v123, v30, v31
    s_add_u32 m0, s47, 30720
    s_add_u32 s42, s48, 30720
    buffer_load_dwordx4 v4, s[16:19], s42 offen lds
    v_exp_f32 v32, v32
    v_exp_f32 v33, v33
    v_exp_f32 v34, v34
    s_waitcnt lgkmcnt(2)
    v_mfma_f32_32x32x16_bf16 v[88:103], v[140:143], v[120:123], v[88:103]
    v_exp_f32 v35, v35
    v_exp_f32 v36, v36
    v_exp_f32 v37, v37
    v_exp_f32 v38, v38
    v_exp_f32 v39, v39
    v_cvt_pk_bf16_f32 v124, v32, v33
    v_cvt_pk_bf16_f32 v125, v34, v35
    v_cvt_pk_bf16_f32 v126, v36, v37
    v_cvt_pk_bf16_f32 v127, v38, v39
    s_waitcnt lgkmcnt(0)
    v_exp_f32 v40, v40
    v_exp_f32 v41, v41
    v_mfma_f32_32x32x16_bf16 v[24:39], v[136:139], v[10:13], v[56:71]
    v_exp_f32 v42, v42
    v_exp_f32 v43, v43
    v_exp_f32 v44, v44
    v_mfma_f32_32x32x16_bf16 v[88:103], v[144:147], v[124:127], v[88:103]
    v_exp_f32 v45, v45
    v_exp_f32 v46, v46
    v_exp_f32 v47, v47
    v_cvt_pk_bf16_f32 v128, v40, v41
    v_cvt_pk_bf16_f32 v129, v42, v43
    v_cvt_pk_bf16_f32 v130, v44, v45
    v_cvt_pk_bf16_f32 v131, v46, v47
    s_add_u32 s42, s32, 147456
    buffer_load_dwordx4 a[32:35], v8, s[20:23], s42 offen
    s_add_u32 s42, s32, 155648
    buffer_load_dwordx4 a[36:39], v8, s[20:23], s42 offen
    v_exp_f32 v48, v48
    v_exp_f32 v49, v49
    v_exp_f32 v50, v50
    v_mfma_f32_32x32x16_bf16 v[104:119], v[140:143], v[128:131], v[104:119]
    v_add_u32 v19, v19, v20
    ds_read_b128 v[140:143], v19
    v_exp_f32 v51, v51
    v_exp_f32 v52, v52
    v_exp_f32 v53, v53
    v_exp_f32 v54, v54
    v_exp_f32 v55, v55
    v_cvt_pk_bf16_f32 v132, v48, v49
    v_cvt_pk_bf16_f32 v133, v50, v51
    v_cvt_pk_bf16_f32 v134, v52, v53
    v_cvt_pk_bf16_f32 v135, v54, v55
    s_setprio 2
    v_mfma_f32_32x32x16_bf16 v[40:55], v[136:139], v[14:17], v[72:87]
    v_exp_f32 v24, v24
    v_exp_f32 v25, v25
    v_exp_f32 v26, v26
    v_mfma_f32_32x32x16_bf16 v[104:119], v[144:147], v[132:135], v[104:119]
    ds_read_b128 v[144:147], v19 offset:512
    ds_read_b128 v[136:139], v18 offset:13312
    v_exp_f32 v27, v27
    v_exp_f32 v28, v28
    v_exp_f32 v29, v29
    v_exp_f32 v30, v30
    v_exp_f32 v31, v31
    v_cvt_pk_bf16_f32 v120, v24, v25
    v_cvt_pk_bf16_f32 v121, v26, v27
    v_cvt_pk_bf16_f32 v122, v28, v29
    v_cvt_pk_bf16_f32 v123, v30, v31
    v_exp_f32 v32, v32
    v_exp_f32 v33, v33
    v_exp_f32 v34, v34
    s_waitcnt lgkmcnt(2)
    v_mfma_f32_32x32x16_bf16 v[88:103], v[140:143], v[120:123], v[88:103]
    v_exp_f32 v35, v35
    v_exp_f32 v36, v36
    v_exp_f32 v37, v37
    v_exp_f32 v38, v38
    v_exp_f32 v39, v39
    v_cvt_pk_bf16_f32 v124, v32, v33
    v_cvt_pk_bf16_f32 v125, v34, v35
    v_cvt_pk_bf16_f32 v126, v36, v37
    v_cvt_pk_bf16_f32 v127, v38, v39
    s_waitcnt lgkmcnt(0)
    v_exp_f32 v40, v40
    v_exp_f32 v41, v41
    v_mfma_f32_32x32x16_bf16 v[24:39], v[136:139], v[10:13], v[56:71]
    v_exp_f32 v42, v42
    v_exp_f32 v43, v43
    v_exp_f32 v44, v44
    v_mfma_f32_32x32x16_bf16 v[88:103], v[144:147], v[124:127], v[88:103]
    v_exp_f32 v45, v45
    v_exp_f32 v46, v46
    v_exp_f32 v47, v47
    v_cvt_pk_bf16_f32 v128, v40, v41
    v_cvt_pk_bf16_f32 v129, v42, v43
    v_cvt_pk_bf16_f32 v130, v44, v45
    v_cvt_pk_bf16_f32 v131, v46, v47
    s_add_u32 s42, s33, 0
    buffer_load_dwordx4 a[40:43], v9, s[24:27], s42 offen
    s_add_u32 s42, s33, 28672
    buffer_load_dwordx4 a[44:47], v9, s[24:27], s42 offen
    v_exp_f32 v48, v48
    v_exp_f32 v49, v49
    v_exp_f32 v50, v50
    v_mfma_f32_32x32x16_bf16 v[104:119], v[140:143], v[128:131], v[104:119]
    ds_read_b128 v[140:143], v19 offset:1024
    v_exp_f32 v51, v51
    v_exp_f32 v52, v52
    v_exp_f32 v53, v53
    v_exp_f32 v54, v54
    v_exp_f32 v55, v55
    v_cvt_pk_bf16_f32 v132, v48, v49
    v_cvt_pk_bf16_f32 v133, v50, v51
    v_cvt_pk_bf16_f32 v134, v52, v53
    v_cvt_pk_bf16_f32 v135, v54, v55
    s_setprio 1
    v_mfma_f32_32x32x16_bf16 v[40:55], v[136:139], v[14:17], v[72:87]
    v_exp_f32 v24, v24
    v_exp_f32 v25, v25
    v_exp_f32 v26, v26
    v_mfma_f32_32x32x16_bf16 v[104:119], v[144:147], v[132:135], v[104:119]
    ds_read_b128 v[144:147], v19 offset:1536
    ds_read_b128 v[136:139], v18 offset:14336
    v_exp_f32 v27, v27
    v_exp_f32 v28, v28
    v_exp_f32 v29, v29
    v_exp_f32 v30, v30
    v_exp_f32 v31, v31
    v_cvt_pk_bf16_f32 v120, v24, v25
    v_cvt_pk_bf16_f32 v121, v26, v27
    v_cvt_pk_bf16_f32 v122, v28, v29
    v_cvt_pk_bf16_f32 v123, v30, v31
    v_exp_f32 v32, v32
    v_exp_f32 v33, v33
    v_exp_f32 v34, v34
    s_waitcnt lgkmcnt(2)
    v_mfma_f32_32x32x16_bf16 v[88:103], v[140:143], v[120:123], v[88:103]
    v_exp_f32 v35, v35
    v_exp_f32 v36, v36
    v_exp_f32 v37, v37
    v_exp_f32 v38, v38
    v_exp_f32 v39, v39
    v_cvt_pk_bf16_f32 v124, v32, v33
    v_cvt_pk_bf16_f32 v125, v34, v35
    v_cvt_pk_bf16_f32 v126, v36, v37
    v_cvt_pk_bf16_f32 v127, v38, v39
    s_waitcnt lgkmcnt(0)
    v_exp_f32 v40, v40
    v_exp_f32 v41, v41
    v_mfma_f32_32x32x16_bf16 v[24:39], v[136:139], v[10:13], v[56:71]
    v_exp_f32 v42, v42
    v_exp_f32 v43, v43
    v_exp_f32 v44, v44
    v_mfma_f32_32x32x16_bf16 v[88:103], v[144:147], v[124:127], v[88:103]
    v_exp_f32 v45, v45
    v_exp_f32 v46, v46
    v_exp_f32 v47, v47
    v_cvt_pk_bf16_f32 v128, v40, v41
    v_cvt_pk_bf16_f32 v129, v42, v43
    v_cvt_pk_bf16_f32 v130, v44, v45
    v_cvt_pk_bf16_f32 v131, v46, v47
    s_add_u32 s42, s33, 57344
    buffer_load_dwordx4 a[48:51], v9, s[24:27], s42 offen
    s_add_u32 s42, s33, 86016
    buffer_load_dwordx4 a[52:55], v9, s[24:27], s42 offen
    v_exp_f32 v48, v48
    v_exp_f32 v49, v49
    v_exp_f32 v50, v50
    v_mfma_f32_32x32x16_bf16 v[104:119], v[140:143], v[128:131], v[104:119]
    ds_read_b128 v[140:143], v19 offset:2048
    v_exp_f32 v51, v51
    v_exp_f32 v52, v52
    v_exp_f32 v53, v53
    v_exp_f32 v54, v54
    v_exp_f32 v55, v55
    v_cvt_pk_bf16_f32 v132, v48, v49
    v_cvt_pk_bf16_f32 v133, v50, v51
    v_cvt_pk_bf16_f32 v134, v52, v53
    v_cvt_pk_bf16_f32 v135, v54, v55
    s_setprio 0
    v_mfma_f32_32x32x16_bf16 v[40:55], v[136:139], v[14:17], v[72:87]
    v_exp_f32 v24, v24
    v_exp_f32 v25, v25
    v_exp_f32 v26, v26
    v_mfma_f32_32x32x16_bf16 v[104:119], v[144:147], v[132:135], v[104:119]
    ds_read_b128 v[144:147], v19 offset:2560
    ds_read_b128 v[136:139], v18 offset:15360
    v_exp_f32 v27, v27
    v_exp_f32 v28, v28
    v_exp_f32 v29, v29
    v_exp_f32 v30, v30
    v_exp_f32 v31, v31
    v_cvt_pk_bf16_f32 v120, v24, v25
    v_cvt_pk_bf16_f32 v121, v26, v27
    v_cvt_pk_bf16_f32 v122, v28, v29
    v_cvt_pk_bf16_f32 v123, v30, v31
    v_exp_f32 v32, v32
    v_exp_f32 v33, v33
    v_exp_f32 v34, v34
    s_waitcnt lgkmcnt(2)
    v_mfma_f32_32x32x16_bf16 v[88:103], v[140:143], v[120:123], v[88:103]
    v_exp_f32 v35, v35
    v_exp_f32 v36, v36
    v_exp_f32 v37, v37
    v_exp_f32 v38, v38
    v_exp_f32 v39, v39
    v_cvt_pk_bf16_f32 v124, v32, v33
    v_cvt_pk_bf16_f32 v125, v34, v35
    v_cvt_pk_bf16_f32 v126, v36, v37
    v_cvt_pk_bf16_f32 v127, v38, v39
    s_waitcnt lgkmcnt(0)
    v_exp_f32 v40, v40
    v_exp_f32 v41, v41
    v_mfma_f32_32x32x16_bf16 v[24:39], v[136:139], v[10:13], v[56:71]
    v_exp_f32 v42, v42
    v_exp_f32 v43, v43
    v_exp_f32 v44, v44
    v_mfma_f32_32x32x16_bf16 v[88:103], v[144:147], v[124:127], v[88:103]
    v_exp_f32 v45, v45
    v_exp_f32 v46, v46
    v_exp_f32 v47, v47
    v_cvt_pk_bf16_f32 v128, v40, v41
    v_cvt_pk_bf16_f32 v129, v42, v43
    v_cvt_pk_bf16_f32 v130, v44, v45
    v_cvt_pk_bf16_f32 v131, v46, v47
    s_add_u32 s42, s33, 114688
    buffer_load_dwordx4 a[56:59], v9, s[24:27], s42 offen
    s_add_u32 s42, s33, 143360
    buffer_load_dwordx4 a[60:63], v9, s[24:27], s42 offen
    v_exp_f32 v48, v48
    v_exp_f32 v49, v49
    v_exp_f32 v50, v50
    v_mfma_f32_32x32x16_bf16 v[104:119], v[140:143], v[128:131], v[104:119]
    ds_read_b128 v[140:143], v19 offset:3072
    v_exp_f32 v51, v51
    v_exp_f32 v52, v52
    v_exp_f32 v53, v53
    v_exp_f32 v54, v54
    v_exp_f32 v55, v55
    v_cvt_pk_bf16_f32 v132, v48, v49
    v_cvt_pk_bf16_f32 v133, v50, v51
    v_cvt_pk_bf16_f32 v134, v52, v53
    v_cvt_pk_bf16_f32 v135, v54, v55
    s_waitcnt vmcnt(8)
    s_barrier
    s_setprio 3
    v_mfma_f32_32x32x16_bf16 v[40:55], v[136:139], v[14:17], v[72:87]
    v_exp_f32 v24, v24
    v_exp_f32 v25, v25
    v_exp_f32 v26, v26
    v_mfma_f32_32x32x16_bf16 v[104:119], v[144:147], v[132:135], v[104:119]
    ds_read_b128 v[144:147], v19 offset:3584
    ds_read_b128 v[136:139], v18 offset:16384
    v_exp_f32 v27, v27
    v_exp_f32 v28, v28
    v_exp_f32 v29, v29
    v_exp_f32 v30, v30
    v_exp_f32 v31, v31
    v_cvt_pk_bf16_f32 v120, v24, v25
    v_cvt_pk_bf16_f32 v121, v26, v27
    v_cvt_pk_bf16_f32 v122, v28, v29
    v_cvt_pk_bf16_f32 v123, v30, v31
    v_exp_f32 v32, v32
    v_exp_f32 v33, v33
    v_exp_f32 v34, v34
    s_waitcnt lgkmcnt(2)
    v_mfma_f32_32x32x16_bf16 v[88:103], v[140:143], v[120:123], v[88:103]
    v_exp_f32 v35, v35
    v_exp_f32 v36, v36
    v_exp_f32 v37, v37
    v_exp_f32 v38, v38
    v_exp_f32 v39, v39
    v_cvt_pk_bf16_f32 v124, v32, v33
    v_cvt_pk_bf16_f32 v125, v34, v35
    v_cvt_pk_bf16_f32 v126, v36, v37
    v_cvt_pk_bf16_f32 v127, v38, v39
    s_waitcnt lgkmcnt(0)
    v_exp_f32 v40, v40
    v_exp_f32 v41, v41
    v_mfma_f32_32x32x16_bf16 v[24:39], v[136:139], v[10:13], v[56:71]
    v_exp_f32 v42, v42
    v_exp_f32 v43, v43
    v_exp_f32 v44, v44
    v_mfma_f32_32x32x16_bf16 v[88:103], v[144:147], v[124:127], v[88:103]
    v_exp_f32 v45, v45
    v_exp_f32 v46, v46
    v_exp_f32 v47, v47
    v_cvt_pk_bf16_f32 v128, v40, v41
    v_cvt_pk_bf16_f32 v129, v42, v43
    v_cvt_pk_bf16_f32 v130, v44, v45
    v_cvt_pk_bf16_f32 v131, v46, v47
    s_add_u32 s42, s33, 172032
    buffer_load_dwordx4 a[64:67], v9, s[24:27], s42 offen
    s_add_u32 s42, s33, 200704
    buffer_load_dwordx4 a[68:71], v9, s[24:27], s42 offen
    v_exp_f32 v48, v48
    v_exp_f32 v49, v49
    v_exp_f32 v50, v50
    v_mfma_f32_32x32x16_bf16 v[104:119], v[140:143], v[128:131], v[104:119]
    v_add_u32 v19, v19, v20
    ds_read_b128 v[140:143], v19
    v_exp_f32 v51, v51
    v_exp_f32 v52, v52
    v_exp_f32 v53, v53
    v_exp_f32 v54, v54
    v_exp_f32 v55, v55
    v_cvt_pk_bf16_f32 v132, v48, v49
    v_cvt_pk_bf16_f32 v133, v50, v51
    v_cvt_pk_bf16_f32 v134, v52, v53
    v_cvt_pk_bf16_f32 v135, v54, v55
    v_mfma_f32_32x32x16_bf16 v[40:55], v[136:139], v[14:17], v[72:87]
    v_exp_f32 v24, v24
    v_exp_f32 v25, v25
    v_exp_f32 v26, v26
    v_mfma_f32_32x32x16_bf16 v[104:119], v[144:147], v[132:135], v[104:119]
    ds_read_b128 v[144:147], v19 offset:512
    ds_read_b128 v[136:139], v18 offset:17408
    v_exp_f32 v27, v27
    v_exp_f32 v28, v28
    v_exp_f32 v29, v29
    v_exp_f32 v30, v30
    v_exp_f32 v31, v31
    v_cvt_pk_bf16_f32 v120, v24, v25
    v_cvt_pk_bf16_f32 v121, v26, v27
    v_cvt_pk_bf16_f32 v122, v28, v29
    v_cvt_pk_bf16_f32 v123, v30, v31
    v_exp_f32 v32, v32
    v_exp_f32 v33, v33
    v_exp_f32 v34, v34
    s_waitcnt lgkmcnt(2)
    v_mfma_f32_32x32x16_bf16 v[88:103], v[140:143], v[120:123], v[88:103]
    v_exp_f32 v35, v35
    v_exp_f32 v36, v36
    v_exp_f32 v37, v37
    v_exp_f32 v38, v38
    v_exp_f32 v39, v39
    v_cvt_pk_bf16_f32 v124, v32, v33
    v_cvt_pk_bf16_f32 v125, v34, v35
    v_cvt_pk_bf16_f32 v126, v36, v37
    v_cvt_pk_bf16_f32 v127, v38, v39
    s_waitcnt lgkmcnt(0)
    v_exp_f32 v40, v40
    v_exp_f32 v41, v41
    v_mfma_f32_32x32x16_bf16 v[24:39], v[136:139], v[10:13], v[56:71]
    v_exp_f32 v42, v42
    v_exp_f32 v43, v43
    v_exp_f32 v44, v44
    v_mfma_f32_32x32x16_bf16 v[88:103], v[144:147], v[124:127], v[88:103]
    v_exp_f32 v45, v45
    v_exp_f32 v46, v46
    v_exp_f32 v47, v47
    v_cvt_pk_bf16_f32 v128, v40, v41
    v_cvt_pk_bf16_f32 v129, v42, v43
    v_cvt_pk_bf16_f32 v130, v44, v45
    v_cvt_pk_bf16_f32 v131, v46, v47
    s_add_u32 s42, s33, 229376
    buffer_load_dwordx4 a[72:75], v9, s[24:27], s42 offen
    s_add_u32 s42, s33, 258048
    buffer_load_dwordx4 a[76:79], v9, s[24:27], s42 offen
    v_exp_f32 v48, v48
    v_exp_f32 v49, v49
    v_exp_f32 v50, v50
    v_mfma_f32_32x32x16_bf16 v[104:119], v[140:143], v[128:131], v[104:119]
    ds_read_b128 v[140:143], v19 offset:1024
    v_exp_f32 v51, v51
    v_exp_f32 v52, v52
    v_exp_f32 v53, v53
    v_exp_f32 v54, v54
    v_exp_f32 v55, v55
    v_cvt_pk_bf16_f32 v132, v48, v49
    v_cvt_pk_bf16_f32 v133, v50, v51
    v_cvt_pk_bf16_f32 v134, v52, v53
    v_cvt_pk_bf16_f32 v135, v54, v55
    v_mfma_f32_32x32x16_bf16 v[40:55], v[136:139], v[14:17], v[72:87]
    v_exp_f32 v24, v24
    v_exp_f32 v25, v25
    v_exp_f32 v26, v26
    v_mfma_f32_32x32x16_bf16 v[104:119], v[144:147], v[132:135], v[104:119]
    ds_read_b128 v[144:147], v19 offset:1536
    ds_read_b128 v[136:139], v18 offset:18432
    v_exp_f32 v27, v27
    v_exp_f32 v28, v28
    v_exp_f32 v29, v29
    v_exp_f32 v30, v30
    v_exp_f32 v31, v31
    v_cvt_pk_bf16_f32 v120, v24, v25
    v_cvt_pk_bf16_f32 v121, v26, v27
    v_cvt_pk_bf16_f32 v122, v28, v29
    v_cvt_pk_bf16_f32 v123, v30, v31
    v_exp_f32 v32, v32
    v_exp_f32 v33, v33
    v_exp_f32 v34, v34
    s_waitcnt lgkmcnt(2)
    v_mfma_f32_32x32x16_bf16 v[88:103], v[140:143], v[120:123], v[88:103]
    v_exp_f32 v35, v35
    v_exp_f32 v36, v36
    v_exp_f32 v37, v37
    v_exp_f32 v38, v38
    v_exp_f32 v39, v39
    v_cvt_pk_bf16_f32 v124, v32, v33
    v_cvt_pk_bf16_f32 v125, v34, v35
    v_cvt_pk_bf16_f32 v126, v36, v37
    v_cvt_pk_bf16_f32 v127, v38, v39
    s_waitcnt lgkmcnt(0)
    v_exp_f32 v40, v40
    v_exp_f32 v41, v41
    v_mfma_f32_32x32x16_bf16 v[24:39], v[136:139], v[10:13], v[56:71]
    v_exp_f32 v42, v42
    v_exp_f32 v43, v43
    v_exp_f32 v44, v44
    v_mfma_f32_32x32x16_bf16 v[88:103], v[144:147], v[124:127], v[88:103]
    v_exp_f32 v45, v45
    v_exp_f32 v46, v46
    v_exp_f32 v47, v47
    v_cvt_pk_bf16_f32 v128, v40, v41
    v_cvt_pk_bf16_f32 v129, v42, v43
    v_cvt_pk_bf16_f32 v130, v44, v45
    v_cvt_pk_bf16_f32 v131, v46, v47
    s_add_u32 s42, s33, 286720
    buffer_load_dwordx4 a[80:83], v9, s[24:27], s42 offen
    s_add_u32 s42, s33, 315392
    buffer_load_dwordx4 a[84:87], v9, s[24:27], s42 offen
    v_exp_f32 v48, v48
    v_exp_f32 v49, v49
    v_exp_f32 v50, v50
    v_mfma_f32_32x32x16_bf16 v[104:119], v[140:143], v[128:131], v[104:119]
    ds_read_b128 v[140:143], v19 offset:2048
    v_exp_f32 v51, v51
    v_exp_f32 v52, v52
    v_exp_f32 v53, v53
    v_exp_f32 v54, v54
    v_exp_f32 v55, v55
    v_cvt_pk_bf16_f32 v132, v48, v49
    v_cvt_pk_bf16_f32 v133, v50, v51
    v_cvt_pk_bf16_f32 v134, v52, v53
    v_cvt_pk_bf16_f32 v135, v54, v55
    v_mfma_f32_32x32x16_bf16 v[40:55], v[136:139], v[14:17], v[72:87]
    v_exp_f32 v24, v24
    v_exp_f32 v25, v25
    v_exp_f32 v26, v26
    v_mfma_f32_32x32x16_bf16 v[104:119], v[144:147], v[132:135], v[104:119]
    ds_read_b128 v[144:147], v19 offset:2560
    ds_read_b128 v[136:139], v18 offset:19456
    v_exp_f32 v27, v27
    v_exp_f32 v28, v28
    v_exp_f32 v29, v29
    v_exp_f32 v30, v30
    v_exp_f32 v31, v31
    v_cvt_pk_bf16_f32 v120, v24, v25
    v_cvt_pk_bf16_f32 v121, v26, v27
    v_cvt_pk_bf16_f32 v122, v28, v29
    v_cvt_pk_bf16_f32 v123, v30, v31
    v_exp_f32 v32, v32
    v_exp_f32 v33, v33
    v_exp_f32 v34, v34
    s_waitcnt lgkmcnt(2)
    v_mfma_f32_32x32x16_bf16 v[88:103], v[140:143], v[120:123], v[88:103]
    v_exp_f32 v35, v35
    v_exp_f32 v36, v36
    v_exp_f32 v37, v37
    v_exp_f32 v38, v38
    v_exp_f32 v39, v39
    v_cvt_pk_bf16_f32 v124, v32, v33
    v_cvt_pk_bf16_f32 v125, v34, v35
    v_cvt_pk_bf16_f32 v126, v36, v37
    v_cvt_pk_bf16_f32 v127, v38, v39
    s_waitcnt lgkmcnt(0)
    v_exp_f32 v40, v40
    v_exp_f32 v41, v41
    v_mfma_f32_32x32x16_bf16 v[24:39], v[136:139], v[10:13], v[56:71]
    v_exp_f32 v42, v42
    v_exp_f32 v43, v43
    v_exp_f32 v44, v44
    v_mfma_f32_32x32x16_bf16 v[88:103], v[144:147], v[124:127], v[88:103]
    v_exp_f32 v45, v45
    v_exp_f32 v46, v46
    v_exp_f32 v47, v47
    v_cvt_pk_bf16_f32 v128, v40, v41
    v_cvt_pk_bf16_f32 v129, v42, v43
    v_cvt_pk_bf16_f32 v130, v44, v45
    v_cvt_pk_bf16_f32 v131, v46, v47
    s_add_u32 s42, s33, 344064
    buffer_load_dwordx4 a[88:91], v9, s[24:27], s42 offen
    s_add_u32 s42, s33, 372736
    buffer_load_dwordx4 a[92:95], v9, s[24:27], s42 offen
    s_cmp_lg_u32 s36, 0
    s_cbranch_scc1 block_kernel_tc2
    global_load_dword v22, v6, s[34:35]
block_kernel_tc2:
    v_exp_f32 v48, v48
    v_exp_f32 v49, v49
    v_exp_f32 v50, v50
    v_mfma_f32_32x32x16_bf16 v[104:119], v[140:143], v[128:131], v[104:119]
    ds_read_b128 v[140:143], v19 offset:3072
    v_exp_f32 v51, v51
    v_exp_f32 v52, v52
    v_exp_f32 v53, v53
    v_exp_f32 v54, v54
    v_exp_f32 v55, v55
    v_cvt_pk_bf16_f32 v132, v48, v49
    v_cvt_pk_bf16_f32 v133, v50, v51
    v_cvt_pk_bf16_f32 v134, v52, v53
    v_cvt_pk_bf16_f32 v135, v54, v55
    s_setprio 2
    v_mfma_f32_32x32x16_bf16 v[40:55], v[136:139], v[14:17], v[72:87]
    v_exp_f32 v24, v24
    v_exp_f32 v25, v25
    v_exp_f32 v26, v26
    v_mfma_f32_32x32x16_bf16 v[104:119], v[144:147], v[132:135], v[104:119]
    ds_read_b128 v[144:147], v19 offset:3584
    ds_read_b128 v[136:139], v18 offset:20480
    v_exp_f32 v27, v27
    v_exp_f32 v28, v28
    v_exp_f32 v29, v29
    v_exp_f32 v30, v30
    v_exp_f32 v31, v31
    v_cvt_pk_bf16_f32 v120, v24, v25
    v_cvt_pk_bf16_f32 v121, v26, v27
    v_cvt_pk_bf16_f32 v122, v28, v29
    v_cvt_pk_bf16_f32 v123, v30, v31
    v_exp_f32 v32, v32
    v_exp_f32 v33, v33
    v_exp_f32 v34, v34
    s_waitcnt lgkmcnt(2)
    v_mfma_f32_32x32x16_bf16 v[88:103], v[140:143], v[120:123], v[88:103]
    v_exp_f32 v35, v35
    v_exp_f32 v36, v36
    v_exp_f32 v37, v37
    v_exp_f32 v38, v38
    v_exp_f32 v39, v39
    v_cvt_pk_bf16_f32 v124, v32, v33
    v_cvt_pk_bf16_f32 v125, v34, v35
    v_cvt_pk_bf16_f32 v126, v36, v37
    v_cvt_pk_bf16_f32 v127, v38, v39
    s_waitcnt lgkmcnt(0)
    v_exp_f32 v40, v40
    v_exp_f32 v41, v41
    v_mfma_f32_32x32x16_bf16 v[24:39], v[136:139], v[10:13], v[56:71]
    v_exp_f32 v42, v42
    v_exp_f32 v43, v43
    v_exp_f32 v44, v44
    v_mfma_f32_32x32x16_bf16 v[88:103], v[144:147], v[124:127], v[88:103]
    v_exp_f32 v45, v45
    v_exp_f32 v46, v46
    v_exp_f32 v47, v47
    v_cvt_pk_bf16_f32 v128, v40, v41
    v_cvt_pk_bf16_f32 v129, v42, v43
    v_cvt_pk_bf16_f32 v130, v44, v45
    v_cvt_pk_bf16_f32 v131, v46, v47
    s_add_u32 s42, s33, 401408
    buffer_load_dwordx4 a[96:99], v9, s[24:27], s42 offen
    s_add_u32 s42, s33, 430080
    buffer_load_dwordx4 a[100:103], v9, s[24:27], s42 offen
    s_cmp_lg_u32 s36, 1
    s_cbranch_scc1 block_kernel_tc3
    global_load_dword v22, v6, s[34:35]
block_kernel_tc3:
    v_exp_f32 v48, v48
    v_exp_f32 v49, v49
    v_exp_f32 v50, v50
    v_mfma_f32_32x32x16_bf16 v[104:119], v[140:143], v[128:131], v[104:119]
    v_add_u32 v19, v19, v20
    ds_read_b128 v[140:143], v19
    v_exp_f32 v51, v51
    v_exp_f32 v52, v52
    v_exp_f32 v53, v53
    v_exp_f32 v54, v54
    v_exp_f32 v55, v55
    v_cvt_pk_bf16_f32 v132, v48, v49
    v_cvt_pk_bf16_f32 v133, v50, v51
    v_cvt_pk_bf16_f32 v134, v52, v53
    v_cvt_pk_bf16_f32 v135, v54, v55
    v_mfma_f32_32x32x16_bf16 v[40:55], v[136:139], v[14:17], v[72:87]
    v_exp_f32 v24, v24
    v_exp_f32 v25, v25
    v_exp_f32 v26, v26
    v_mfma_f32_32x32x16_bf16 v[104:119], v[144:147], v[132:135], v[104:119]
    ds_read_b128 v[144:147], v19 offset:512
    ds_read_b128 v[136:139], v18 offset:21504
    v_exp_f32 v27, v27
    v_exp_f32 v28, v28
    v_exp_f32 v29, v29
    v_exp_f32 v30, v30
    v_exp_f32 v31, v31
    v_cvt_pk_bf16_f32 v120, v24, v25
    v_cvt_pk_bf16_f32 v121, v26, v27
    v_cvt_pk_bf16_f32 v122, v28, v29
    v_cvt_pk_bf16_f32 v123, v30, v31
    v_exp_f32 v32, v32
    v_exp_f32 v33, v33
    v_exp_f32 v34, v34
    s_waitcnt lgkmcnt(2)
    v_mfma_f32_32x32x16_bf16 v[88:103], v[140:143], v[120:123], v[88:103]
    v_exp_f32 v35, v35
    v_exp_f32 v36, v36
    v_exp_f32 v37, v37
    v_exp_f32 v38, v38
    v_exp_f32 v39, v39
    v_cvt_pk_bf16_f32 v124, v32, v33
    v_cvt_pk_bf16_f32 v125, v34, v35
    v_cvt_pk_bf16_f32 v126, v36, v37
    v_cvt_pk_bf16_f32 v127, v38, v39
    s_waitcnt lgkmcnt(0)
    v_exp_f32 v40, v40
    v_exp_f32 v41, v41
    v_mfma_f32_32x32x16_bf16 v[24:39], v[136:139], v[10:13], v[56:71]
    v_exp_f32 v42, v42
    v_exp_f32 v43, v43
    v_exp_f32 v44, v44
    v_mfma_f32_32x32x16_bf16 v[88:103], v[144:147], v[124:127], v[88:103]
    v_exp_f32 v45, v45
    v_exp_f32 v46, v46
    v_exp_f32 v47, v47
    v_cvt_pk_bf16_f32 v128, v40, v41
    v_cvt_pk_bf16_f32 v129, v42, v43
    v_cvt_pk_bf16_f32 v130, v44, v45
    v_cvt_pk_bf16_f32 v131, v46, v47
    s_lshr_b32 s42, s40, 3
    s_lshl_b32 s43, s39, 2
    s_add_u32 s42, s42, s43
    s_lshl_b32 s42, s42, 16
    s_add_u32 s20, s6, s42
    s_addc_u32 s21, s7, 0
    s_mov_b32 s22, 65536
    s_mov_b32 s23, 0x20000
    s_lshl_b32 s42, s36, 10
    s_add_u32 m0, s42, 155648
    s_lshl_b32 s42, s36, 13
    s_and_b32 s43, s40, 7
    s_lshl_b32 s43, s43, 7
    s_add_u32 s42, s42, s43
    buffer_load_dwordx4 v7, s[20:23], s42 offen lds
    s_add_u32 s20, s4, 6291456
    s_addc_u32 s21, s5, 0
    s_mov_b32 s22, 2097152
    s_mov_b32 s23, 0x20000
    s_cmp_lg_u32 s36, 2
    s_cbranch_scc1 block_kernel_tc4
    global_load_dword v22, v6, s[34:35]
block_kernel_tc4:
    v_exp_f32 v48, v48
    v_exp_f32 v49, v49
    v_exp_f32 v50, v50
    v_mfma_f32_32x32x16_bf16 v[104:119], v[140:143], v[128:131], v[104:119]
    ds_read_b128 v[140:143], v19 offset:1024
    v_exp_f32 v51, v51
    v_exp_f32 v52, v52
    v_exp_f32 v53, v53
    v_exp_f32 v54, v54
    v_exp_f32 v55, v55
    v_cvt_pk_bf16_f32 v132, v48, v49
    v_cvt_pk_bf16_f32 v133, v50, v51
    v_cvt_pk_bf16_f32 v134, v52, v53
    v_cvt_pk_bf16_f32 v135, v54, v55
    v_mfma_f32_32x32x16_bf16 v[40:55], v[136:139], v[14:17], v[72:87]
    v_exp_f32 v24, v24
    v_exp_f32 v25, v25
    v_exp_f32 v26, v26
    v_mfma_f32_32x32x16_bf16 v[104:119], v[144:147], v[132:135], v[104:119]
    ds_read_b128 v[144:147], v19 offset:1536
    ds_read_b128 v[136:139], v18 offset:22528
    v_exp_f32 v27, v27
    v_exp_f32 v28, v28
    v_exp_f32 v29, v29
    v_exp_f32 v30, v30
    v_exp_f32 v31, v31
    v_cvt_pk_bf16_f32 v120, v24, v25
    v_cvt_pk_bf16_f32 v121, v26, v27
    v_cvt_pk_bf16_f32 v122, v28, v29
    v_cvt_pk_bf16_f32 v123, v30, v31
    v_exp_f32 v32, v32
    v_exp_f32 v33, v33
    v_exp_f32 v34, v34
    s_waitcnt lgkmcnt(2)
    v_mfma_f32_32x32x16_bf16 v[88:103], v[140:143], v[120:123], v[88:103]
    v_exp_f32 v35, v35
    v_exp_f32 v36, v36
    v_exp_f32 v37, v37
    v_exp_f32 v38, v38
    v_exp_f32 v39, v39
    v_cvt_pk_bf16_f32 v124, v32, v33
    v_cvt_pk_bf16_f32 v125, v34, v35
    v_cvt_pk_bf16_f32 v126, v36, v37
    v_cvt_pk_bf16_f32 v127, v38, v39
    s_waitcnt lgkmcnt(0)
    v_exp_f32 v40, v40
    v_exp_f32 v41, v41
    v_mfma_f32_32x32x16_bf16 v[24:39], v[136:139], v[10:13], v[56:71]
    v_exp_f32 v42, v42
    v_exp_f32 v43, v43
    v_exp_f32 v44, v44
    v_mfma_f32_32x32x16_bf16 v[88:103], v[144:147], v[124:127], v[88:103]
    v_exp_f32 v45, v45
    v_exp_f32 v46, v46
    v_exp_f32 v47, v47
    v_cvt_pk_bf16_f32 v128, v40, v41
    v_cvt_pk_bf16_f32 v129, v42, v43
    v_cvt_pk_bf16_f32 v130, v44, v45
    v_cvt_pk_bf16_f32 v131, v46, v47
    s_cmp_lg_u32 s36, 0
    s_cbranch_scc1 block_kernel_tc5
    global_load_dword v22, v21, s[4:5]
block_kernel_tc5:
    s_cmp_lg_u32 s36, 3
    s_cbranch_scc1 block_kernel_tc6
    global_load_dword v22, v6, s[34:35]
block_kernel_tc6:
    v_exp_f32 v48, v48
    v_exp_f32 v49, v49
    v_exp_f32 v50, v50
    v_mfma_f32_32x32x16_bf16 v[104:119], v[140:143], v[128:131], v[104:119]
    ds_read_b128 v[140:143], v19 offset:2048
    v_exp_f32 v51, v51
    v_exp_f32 v52, v52
    v_exp_f32 v53, v53
    v_exp_f32 v54, v54
    v_exp_f32 v55, v55
    v_cvt_pk_bf16_f32 v132, v48, v49
    v_cvt_pk_bf16_f32 v133, v50, v51
    v_cvt_pk_bf16_f32 v134, v52, v53
    v_cvt_pk_bf16_f32 v135, v54, v55
    v_mfma_f32_32x32x16_bf16 v[40:55], v[136:139], v[14:17], v[72:87]
    v_exp_f32 v24, v24
    v_exp_f32 v25, v25
    v_exp_f32 v26, v26
    v_mfma_f32_32x32x16_bf16 v[104:119], v[144:147], v[132:135], v[104:119]
    ds_read_b128 v[144:147], v19 offset:2560
    ds_read_b128 v[136:139], v18 offset:23552
    v_exp_f32 v27, v27
    v_exp_f32 v28, v28
    v_exp_f32 v29, v29
    v_exp_f32 v30, v30
    v_exp_f32 v31, v31
    v_cvt_pk_bf16_f32 v120, v24, v25
    v_cvt_pk_bf16_f32 v121, v26, v27
    v_cvt_pk_bf16_f32 v122, v28, v29
    v_cvt_pk_bf16_f32 v123, v30, v31
    v_exp_f32 v32, v32
    v_exp_f32 v33, v33
    v_exp_f32 v34, v34
    s_waitcnt lgkmcnt(2)
    v_mfma_f32_32x32x16_bf16 v[88:103], v[140:143], v[120:123], v[88:103]
    v_exp_f32 v35, v35
    v_exp_f32 v36, v36
    v_exp_f32 v37, v37
    v_exp_f32 v38, v38
    v_exp_f32 v39, v39
    v_cvt_pk_bf16_f32 v124, v32, v33
    v_cvt_pk_bf16_f32 v125, v34, v35
    v_cvt_pk_bf16_f32 v126, v36, v37
    v_cvt_pk_bf16_f32 v127, v38, v39
    s_waitcnt lgkmcnt(0)
    v_exp_f32 v40, v40
    v_exp_f32 v41, v41
    v_mfma_f32_32x32x16_bf16 v[24:39], v[136:139], v[10:13], v[56:71]
    v_exp_f32 v42, v42
    v_exp_f32 v43, v43
    v_exp_f32 v44, v44
    v_mfma_f32_32x32x16_bf16 v[88:103], v[144:147], v[124:127], v[88:103]
    v_exp_f32 v45, v45
    v_exp_f32 v46, v46
    v_exp_f32 v47, v47
    v_cvt_pk_bf16_f32 v128, v40, v41
    v_cvt_pk_bf16_f32 v129, v42, v43
    v_cvt_pk_bf16_f32 v130, v44, v45
    v_cvt_pk_bf16_f32 v131, v46, v47
    s_cmp_lg_u32 s36, 1
    s_cbranch_scc1 block_kernel_tc7
    global_load_dword v22, v21, s[4:5]
block_kernel_tc7:
    s_cmp_lg_u32 s36, 4
    s_cbranch_scc1 block_kernel_tc8
    global_load_dword v22, v6, s[34:35]
block_kernel_tc8:
    v_exp_f32 v48, v48
    v_exp_f32 v49, v49
    v_exp_f32 v50, v50
    v_mfma_f32_32x32x16_bf16 v[104:119], v[140:143], v[128:131], v[104:119]
    ds_read_b128 v[140:143], v19 offset:3072
    v_exp_f32 v51, v51
    v_exp_f32 v52, v52
    v_exp_f32 v53, v53
    v_exp_f32 v54, v54
    v_exp_f32 v55, v55
    v_cvt_pk_bf16_f32 v132, v48, v49
    v_cvt_pk_bf16_f32 v133, v50, v51
    v_cvt_pk_bf16_f32 v134, v52, v53
    v_cvt_pk_bf16_f32 v135, v54, v55
    s_setprio 1
    v_mfma_f32_32x32x16_bf16 v[40:55], v[136:139], v[14:17], v[72:87]
    v_exp_f32 v24, v24
    v_exp_f32 v25, v25
    v_exp_f32 v26, v26
    v_mfma_f32_32x32x16_bf16 v[104:119], v[144:147], v[132:135], v[104:119]
    ds_read_b128 v[144:147], v19 offset:3584
    ds_read_b128 v[136:139], v18 offset:24576
    v_exp_f32 v27, v27
    v_exp_f32 v28, v28
    v_exp_f32 v29, v29
    v_exp_f32 v30, v30
    v_exp_f32 v31, v31
    v_cvt_pk_bf16_f32 v120, v24, v25
    v_cvt_pk_bf16_f32 v121, v26, v27
    v_cvt_pk_bf16_f32 v122, v28, v29
    v_cvt_pk_bf16_f32 v123, v30, v31
    v_exp_f32 v32, v32
    v_exp_f32 v33, v33
    v_exp_f32 v34, v34
    s_waitcnt lgkmcnt(2)
    v_mfma_f32_32x32x16_bf16 v[88:103], v[140:143], v[120:123], v[88:103]
    v_exp_f32 v35, v35
    v_exp_f32 v36, v36
    v_exp_f32 v37, v37
    v_exp_f32 v38, v38
    v_exp_f32 v39, v39
    v_cvt_pk_bf16_f32 v124, v32, v33
    v_cvt_pk_bf16_f32 v125, v34, v35
    v_cvt_pk_bf16_f32 v126, v36, v37
    v_cvt_pk_bf16_f32 v127, v38, v39
    s_waitcnt lgkmcnt(0)
    v_exp_f32 v40, v40
    v_exp_f32 v41, v41
    v_mfma_f32_32x32x16_bf16 v[24:39], v[136:139], v[10:13], v[56:71]
    v_exp_f32 v42, v42
    v_exp_f32 v43, v43
    v_exp_f32 v44, v44
    v_mfma_f32_32x32x16_bf16 v[88:103], v[144:147], v[124:127], v[88:103]
    v_exp_f32 v45, v45
    v_exp_f32 v46, v46
    v_exp_f32 v47, v47
    v_cvt_pk_bf16_f32 v128, v40, v41
    v_cvt_pk_bf16_f32 v129, v42, v43
    v_cvt_pk_bf16_f32 v130, v44, v45
    v_cvt_pk_bf16_f32 v131, v46, v47
    s_cmp_lg_u32 s36, 2
    s_cbranch_scc1 block_kernel_tc9
    global_load_dword v22, v21, s[4:5]
block_kernel_tc9:
    s_cmp_lg_u32 s36, 5
    s_cbranch_scc1 block_kernel_tc10
    global_load_dword v22, v6, s[34:35]
block_kernel_tc10:
    v_exp_f32 v48, v48
    v_exp_f32 v49, v49
    v_exp_f32 v50, v50
    v_mfma_f32_32x32x16_bf16 v[104:119], v[140:143], v[128:131], v[104:119]
    v_add_u32 v19, v19, v20
    ds_read_b128 v[140:143], v19
    v_exp_f32 v51, v51
    v_exp_f32 v52, v52
    v_exp_f32 v53, v53
    v_exp_f32 v54, v54
    v_exp_f32 v55, v55
    v_cvt_pk_bf16_f32 v132, v48, v49
    v_cvt_pk_bf16_f32 v133, v50, v51
    v_cvt_pk_bf16_f32 v134, v52, v53
    v_cvt_pk_bf16_f32 v135, v54, v55
    v_mfma_f32_32x32x16_bf16 v[40:55], v[136:139], v[14:17], v[72:87]
    v_exp_f32 v24, v24
    v_exp_f32 v25, v25
    v_exp_f32 v26, v26
    v_mfma_f32_32x32x16_bf16 v[104:119], v[144:147], v[132:135], v[104:119]
    ds_read_b128 v[144:147], v19 offset:512
    ds_read_b128 v[136:139], v18 offset:25600
    v_exp_f32 v27, v27
    v_exp_f32 v28, v28
    v_exp_f32 v29, v29
    v_exp_f32 v30, v30
    v_exp_f32 v31, v31
    v_cvt_pk_bf16_f32 v120, v24, v25
    v_cvt_pk_bf16_f32 v121, v26, v27
    v_cvt_pk_bf16_f32 v122, v28, v29
    v_cvt_pk_bf16_f32 v123, v30, v31
    v_exp_f32 v32, v32
    v_exp_f32 v33, v33
    v_exp_f32 v34, v34
    s_waitcnt lgkmcnt(2)
    v_mfma_f32_32x32x16_bf16 v[88:103], v[140:143], v[120:123], v[88:103]
    v_exp_f32 v35, v35
    v_exp_f32 v36, v36
    v_exp_f32 v37, v37
    v_exp_f32 v38, v38
    v_exp_f32 v39, v39
    v_cvt_pk_bf16_f32 v124, v32, v33
    v_cvt_pk_bf16_f32 v125, v34, v35
    v_cvt_pk_bf16_f32 v126, v36, v37
    v_cvt_pk_bf16_f32 v127, v38, v39
    s_waitcnt lgkmcnt(0)
    v_exp_f32 v40, v40
    v_exp_f32 v41, v41
    v_mfma_f32_32x32x16_bf16 v[24:39], v[136:139], v[10:13], v[56:71]
    v_exp_f32 v42, v42
    v_exp_f32 v43, v43
    v_exp_f32 v44, v44
    v_mfma_f32_32x32x16_bf16 v[88:103], v[144:147], v[124:127], v[88:103]
    v_exp_f32 v45, v45
    v_exp_f32 v46, v46
    v_exp_f32 v47, v47
    v_cvt_pk_bf16_f32 v128, v40, v41
    v_cvt_pk_bf16_f32 v129, v42, v43
    v_cvt_pk_bf16_f32 v130, v44, v45
    v_cvt_pk_bf16_f32 v131, v46, v47
    s_cmp_lg_u32 s36, 3
    s_cbranch_scc1 block_kernel_tc11
    global_load_dword v22, v21, s[4:5]
block_kernel_tc11:
    s_cmp_lg_u32 s36, 6
    s_cbranch_scc1 block_kernel_tc12
    global_load_dword v22, v6, s[34:35]
block_kernel_tc12:
    v_exp_f32 v48, v48
    v_exp_f32 v49, v49
    v_exp_f32 v50, v50
    v_mfma_f32_32x32x16_bf16 v[104:119], v[140:143], v[128:131], v[104:119]
    ds_read_b128 v[140:143], v19 offset:1024
    v_exp_f32 v51, v51
    v_exp_f32 v52, v52
    v_exp_f32 v53, v53
    v_exp_f32 v54, v54
    v_exp_f32 v55, v55
    v_cvt_pk_bf16_f32 v132, v48, v49
    v_cvt_pk_bf16_f32 v133, v50, v51
    v_cvt_pk_bf16_f32 v134, v52, v53
    v_cvt_pk_bf16_f32 v135, v54, v55
    v_mfma_f32_32x32x16_bf16 v[40:55], v[136:139], v[14:17], v[72:87]
    v_exp_f32 v24, v24
    v_exp_f32 v25, v25
    v_exp_f32 v26, v26
    v_mfma_f32_32x32x16_bf16 v[104:119], v[144:147], v[132:135], v[104:119]
    ds_read_b128 v[144:147], v19 offset:1536
    ds_read_b128 v[136:139], v18 offset:26624
    v_exp_f32 v27, v27
    v_exp_f32 v28, v28
    v_exp_f32 v29, v29
    v_exp_f32 v30, v30
    v_exp_f32 v31, v31
    v_cvt_pk_bf16_f32 v120, v24, v25
    v_cvt_pk_bf16_f32 v121, v26, v27
    v_cvt_pk_bf16_f32 v122, v28, v29
    v_cvt_pk_bf16_f32 v123, v30, v31
    v_exp_f32 v32, v32
    v_exp_f32 v33, v33
    v_exp_f32 v34, v34
    s_waitcnt lgkmcnt(2)
    v_mfma_f32_32x32x16_bf16 v[88:103], v[140:143], v[120:123], v[88:103]
    v_exp_f32 v35, v35
    v_exp_f32 v36, v36
    v_exp_f32 v37, v37
    v_exp_f32 v38, v38
    v_exp_f32 v39, v39
    v_cvt_pk_bf16_f32 v124, v32, v33
    v_cvt_pk_bf16_f32 v125, v34, v35
    v_cvt_pk_bf16_f32 v126, v36, v37
    v_cvt_pk_bf16_f32 v127, v38, v39
    s_waitcnt lgkmcnt(0)
    v_exp_f32 v40, v40
    v_exp_f32 v41, v41
    v_mfma_f32_32x32x16_bf16 v[24:39], v[136:139], v[10:13], v[56:71]
    v_exp_f32 v42, v42
    v_exp_f32 v43, v43
    v_exp_f32 v44, v44
    v_mfma_f32_32x32x16_bf16 v[88:103], v[144:147], v[124:127], v[88:103]
    v_exp_f32 v45, v45
    v_exp_f32 v46, v46
    v_exp_f32 v47, v47
    v_cvt_pk_bf16_f32 v128, v40, v41
    v_cvt_pk_bf16_f32 v129, v42, v43
    v_cvt_pk_bf16_f32 v130, v44, v45
    v_cvt_pk_bf16_f32 v131, v46, v47
    s_cmp_lg_u32 s36, 4
    s_cbranch_scc1 block_kernel_tc13
    global_load_dword v22, v21, s[4:5]
block_kernel_tc13:
    s_cmp_lg_u32 s36, 7
    s_cbranch_scc1 block_kernel_tc14
    global_load_dword v22, v6, s[34:35]
block_kernel_tc14:
    v_exp_f32 v48, v48
    v_exp_f32 v49, v49
    v_exp_f32 v50, v50
    v_mfma_f32_32x32x16_bf16 v[104:119], v[140:143], v[128:131], v[104:119]
    ds_read_b128 v[140:143], v19 offset:2048
    v_exp_f32 v51, v51
    v_exp_f32 v52, v52
    v_exp_f32 v53, v53
    v_exp_f32 v54, v54
    v_exp_f32 v55, v55
    v_cvt_pk_bf16_f32 v132, v48, v49
    v_cvt_pk_bf16_f32 v133, v50, v51
    v_cvt_pk_bf16_f32 v134, v52, v53
    v_cvt_pk_bf16_f32 v135, v54, v55
    v_mfma_f32_32x32x16_bf16 v[40:55], v[136:139], v[14:17], v[72:87]
    v_exp_f32 v24, v24
    v_exp_f32 v25, v25
    v_exp_f32 v26, v26
    v_mfma_f32_32x32x16_bf16 v[104:119], v[144:147], v[132:135], v[104:119]
    ds_read_b128 v[144:147], v19 offset:2560
    ds_read_b128 v[136:139], v18 offset:27648
    v_exp_f32 v27, v27
    v_exp_f32 v28, v28
    v_exp_f32 v29, v29
    v_exp_f32 v30, v30
    v_exp_f32 v31, v31
    v_cvt_pk_bf16_f32 v120, v24, v25
    v_cvt_pk_bf16_f32 v121, v26, v27
    v_cvt_pk_bf16_f32 v122, v28, v29
    v_cvt_pk_bf16_f32 v123, v30, v31
    v_exp_f32 v32, v32
    v_exp_f32 v33, v33
    v_exp_f32 v34, v34
    s_waitcnt lgkmcnt(2)
    v_mfma_f32_32x32x16_bf16 v[88:103], v[140:143], v[120:123], v[88:103]
    v_exp_f32 v35, v35
    v_exp_f32 v36, v36
    v_exp_f32 v37, v37
    v_exp_f32 v38, v38
    v_exp_f32 v39, v39
    v_cvt_pk_bf16_f32 v124, v32, v33
    v_cvt_pk_bf16_f32 v125, v34, v35
    v_cvt_pk_bf16_f32 v126, v36, v37
    v_cvt_pk_bf16_f32 v127, v38, v39
    s_waitcnt lgkmcnt(0)
    v_exp_f32 v40, v40
    v_exp_f32 v41, v41
    v_mfma_f32_32x32x16_bf16 v[24:39], v[136:139], v[10:13], v[56:71]
    v_exp_f32 v42, v42
    v_exp_f32 v43, v43
    v_exp_f32 v44, v44
    v_mfma_f32_32x32x16_bf16 v[88:103], v[144:147], v[124:127], v[88:103]
    v_exp_f32 v45, v45
    v_exp_f32 v46, v46
    v_exp_f32 v47, v47
    v_cvt_pk_bf16_f32 v128, v40, v41
    v_cvt_pk_bf16_f32 v129, v42, v43
    v_cvt_pk_bf16_f32 v130, v44, v45
    v_cvt_pk_bf16_f32 v131, v46, v47
    s_cmp_lg_u32 s36, 5
    s_cbranch_scc1 block_kernel_tc15
    global_load_dword v22, v21, s[4:5]
block_kernel_tc15:
    v_exp_f32 v48, v48
    v_exp_f32 v49, v49
    v_exp_f32 v50, v50
    v_mfma_f32_32x32x16_bf16 v[104:119], v[140:143], v[128:131], v[104:119]
    ds_read_b128 v[140:143], v19 offset:3072
    v_exp_f32 v51, v51
    v_exp_f32 v52, v52
    v_exp_f32 v53, v53
    v_exp_f32 v54, v54
    v_exp_f32 v55, v55
    v_cvt_pk_bf16_f32 v132, v48, v49
    v_cvt_pk_bf16_f32 v133, v50, v51
    v_cvt_pk_bf16_f32 v134, v52, v53
    v_cvt_pk_bf16_f32 v135, v54, v55
    v_mfma_f32_32x32x16_bf16 v[40:55], v[136:139], v[14:17], v[72:87]
    v_exp_f32 v24, v24
    v_exp_f32 v25, v25
    v_exp_f32 v26, v26
    v_mfma_f32_32x32x16_bf16 v[104:119], v[144:147], v[132:135], v[104:119]
    ds_read_b128 v[144:147], v19 offset:3584
    ds_read_b128 v[136:139], v18 offset:28672
    v_exp_f32 v27, v27
    v_exp_f32 v28, v28
    v_exp_f32 v29, v29
    v_exp_f32 v30, v30
    v_exp_f32 v31, v31
    v_cvt_pk_bf16_f32 v120, v24, v25
    v_cvt_pk_bf16_f32 v121, v26, v27
    v_cvt_pk_bf16_f32 v122, v28, v29
    v_cvt_pk_bf16_f32 v123, v30, v31
    v_exp_f32 v32, v32
    v_exp_f32 v33, v33
    v_exp_f32 v34, v34
    s_waitcnt lgkmcnt(2)
    v_mfma_f32_32x32x16_bf16 v[88:103], v[140:143], v[120:123], v[88:103]
    v_exp_f32 v35, v35
    v_exp_f32 v36, v36
    v_exp_f32 v37, v37
    v_exp_f32 v38, v38
    v_exp_f32 v39, v39
    v_cvt_pk_bf16_f32 v124, v32, v33
    v_cvt_pk_bf16_f32 v125, v34, v35
    v_cvt_pk_bf16_f32 v126, v36, v37
    v_cvt_pk_bf16_f32 v127, v38, v39
    s_waitcnt lgkmcnt(0)
    v_exp_f32 v40, v40
    v_exp_f32 v41, v41
    v_mfma_f32_32x32x16_bf16 v[24:39], v[136:139], v[10:13], v[56:71]
    v_exp_f32 v42, v42
    v_exp_f32 v43, v43
    v_exp_f32 v44, v44
    v_mfma_f32_32x32x16_bf16 v[88:103], v[144:147], v[124:127], v[88:103]
    v_exp_f32 v45, v45
    v_exp_f32 v46, v46
    v_exp_f32 v47, v47
    v_cvt_pk_bf16_f32 v128, v40, v41
    v_cvt_pk_bf16_f32 v129, v42, v43
    v_cvt_pk_bf16_f32 v130, v44, v45
    v_cvt_pk_bf16_f32 v131, v46, v47
    s_cmp_lg_u32 s36, 6
    s_cbranch_scc1 block_kernel_tc16
    global_load_dword v22, v21, s[4:5]
block_kernel_tc16:
    v_exp_f32 v48, v48
    v_exp_f32 v49, v49
    v_exp_f32 v50, v50
    v_mfma_f32_32x32x16_bf16 v[104:119], v[140:143], v[128:131], v[104:119]
    v_add_u32 v19, v19, v20
    ds_read_b128 v[140:143], v19
    v_exp_f32 v51, v51
    v_exp_f32 v52, v52
    v_exp_f32 v53, v53
    v_exp_f32 v54, v54
    v_exp_f32 v55, v55
    v_cvt_pk_bf16_f32 v132, v48, v49
    v_cvt_pk_bf16_f32 v133, v50, v51
    v_cvt_pk_bf16_f32 v134, v52, v53
    v_cvt_pk_bf16_f32 v135, v54, v55
    s_setprio 0
    v_mfma_f32_32x32x16_bf16 v[40:55], v[136:139], v[14:17], v[72:87]
    v_exp_f32 v24, v24
    v_exp_f32 v25, v25
    v_exp_f32 v26, v26
    v_mfma_f32_32x32x16_bf16 v[104:119], v[144:147], v[132:135], v[104:119]
    ds_read_b128 v[144:147], v19 offset:512
    ds_read_b128 v[136:139], v18 offset:29696
    v_exp_f32 v27, v27
    v_exp_f32 v28, v28
    v_exp_f32 v29, v29
    v_exp_f32 v30, v30
    v_exp_f32 v31, v31
    v_cvt_pk_bf16_f32 v120, v24, v25
    v_cvt_pk_bf16_f32 v121, v26, v27
    v_cvt_pk_bf16_f32 v122, v28, v29
    v_cvt_pk_bf16_f32 v123, v30, v31
    v_exp_f32 v32, v32
    v_exp_f32 v33, v33
    v_exp_f32 v34, v34
    s_waitcnt lgkmcnt(2)
    v_mfma_f32_32x32x16_bf16 v[88:103], v[140:143], v[120:123], v[88:103]
    v_exp_f32 v35, v35
    v_exp_f32 v36, v36
    v_exp_f32 v37, v37
    v_exp_f32 v38, v38
    v_exp_f32 v39, v39
    v_cvt_pk_bf16_f32 v124, v32, v33
    v_cvt_pk_bf16_f32 v125, v34, v35
    v_cvt_pk_bf16_f32 v126, v36, v37
    v_cvt_pk_bf16_f32 v127, v38, v39
    s_waitcnt lgkmcnt(0)
    v_exp_f32 v40, v40
    v_exp_f32 v41, v41
    v_mfma_f32_32x32x16_bf16 v[24:39], v[136:139], v[10:13], v[56:71]
    v_exp_f32 v42, v42
    v_exp_f32 v43, v43
    v_exp_f32 v44, v44
    v_mfma_f32_32x32x16_bf16 v[88:103], v[144:147], v[124:127], v[88:103]
    v_exp_f32 v45, v45
    v_exp_f32 v46, v46
    v_exp_f32 v47, v47
    v_cvt_pk_bf16_f32 v128, v40, v41
    v_cvt_pk_bf16_f32 v129, v42, v43
    v_cvt_pk_bf16_f32 v130, v44, v45
    v_cvt_pk_bf16_f32 v131, v46, v47
    s_cmp_lg_u32 s36, 7
    s_cbranch_scc1 block_kernel_tc17
    global_load_dword v22, v21, s[4:5]
block_kernel_tc17:
    v_exp_f32 v48, v48
    v_exp_f32 v49, v49
    v_exp_f32 v50, v50
    v_mfma_f32_32x32x16_bf16 v[104:119], v[140:143], v[128:131], v[104:119]
    ds_read_b128 v[140:143], v19 offset:1024
    v_exp_f32 v51, v51
    v_exp_f32 v52, v52
    v_exp_f32 v53, v53
    v_exp_f32 v54, v54
    v_exp_f32 v55, v55
    v_cvt_pk_bf16_f32 v132, v48, v49
    v_cvt_pk_bf16_f32 v133, v50, v51
    v_cvt_pk_bf16_f32 v134, v52, v53
    v_cvt_pk_bf16_f32 v135, v54, v55
    v_mfma_f32_32x32x16_bf16 v[40:55], v[136:139], v[14:17], v[72:87]
    v_exp_f32 v24, v24
    v_exp_f32 v25, v25
    v_exp_f32 v26, v26
    v_mfma_f32_32x32x16_bf16 v[104:119], v[144:147], v[132:135], v[104:119]
    ds_read_b128 v[144:147], v19 offset:1536
    ds_read_b128 v[136:139], v18 offset:30720
    v_exp_f32 v27, v27
    v_exp_f32 v28, v28
    v_exp_f32 v29, v29
    v_exp_f32 v30, v30
    v_exp_f32 v31, v31
    v_cvt_pk_bf16_f32 v120, v24, v25
    v_cvt_pk_bf16_f32 v121, v26, v27
    v_cvt_pk_bf16_f32 v122, v28, v29
    v_cvt_pk_bf16_f32 v123, v30, v31
    v_exp_f32 v32, v32
    v_exp_f32 v33, v33
    v_exp_f32 v34, v34
    s_waitcnt lgkmcnt(2)
    v_mfma_f32_32x32x16_bf16 v[88:103], v[140:143], v[120:123], v[88:103]
    v_exp_f32 v35, v35
    v_exp_f32 v36, v36
    v_exp_f32 v37, v37
    v_exp_f32 v38, v38
    v_exp_f32 v39, v39
    v_cvt_pk_bf16_f32 v124, v32, v33
    v_cvt_pk_bf16_f32 v125, v34, v35
    v_cvt_pk_bf16_f32 v126, v36, v37
    v_cvt_pk_bf16_f32 v127, v38, v39
    s_waitcnt lgkmcnt(0)
    v_exp_f32 v40, v40
    v_exp_f32 v41, v41
    v_mfma_f32_32x32x16_bf16 v[24:39], v[136:139], v[10:13], v[56:71]
    v_exp_f32 v42, v42
    v_exp_f32 v43, v43
    v_exp_f32 v44, v44
    v_mfma_f32_32x32x16_bf16 v[88:103], v[144:147], v[124:127], v[88:103]
    v_exp_f32 v45, v45
    v_exp_f32 v46, v46
    v_exp_f32 v47, v47
    v_cvt_pk_bf16_f32 v128, v40, v41
    v_cvt_pk_bf16_f32 v129, v42, v43
    v_cvt_pk_bf16_f32 v130, v44, v45
    v_cvt_pk_bf16_f32 v131, v46, v47
    v_lshlrev_b32 v6, 2, v2
    buffer_load_dword v21, v6, s[28:31], 0 offen sc1
    v_exp_f32 v48, v48
    v_exp_f32 v49, v49
    v_exp_f32 v50, v50
    v_mfma_f32_32x32x16_bf16 v[104:119], v[140:143], v[128:131], v[104:119]
    ds_read_b128 v[140:143], v19 offset:2048
    v_exp_f32 v51, v51
    v_exp_f32 v52, v52
    v_exp_f32 v53, v53
    v_exp_f32 v54, v54
    v_exp_f32 v55, v55
    v_cvt_pk_bf16_f32 v132, v48, v49
    v_cvt_pk_bf16_f32 v133, v50, v51
    v_cvt_pk_bf16_f32 v134, v52, v53
    v_cvt_pk_bf16_f32 v135, v54, v55
    v_mfma_f32_32x32x16_bf16 v[40:55], v[136:139], v[14:17], v[72:87]
    v_exp_f32 v24, v24
    v_exp_f32 v25, v25
    v_exp_f32 v26, v26
    v_mfma_f32_32x32x16_bf16 v[104:119], v[144:147], v[132:135], v[104:119]
    ds_read_b128 v[144:147], v19 offset:2560
    ds_read_b128 v[136:139], v18 offset:31744
    v_exp_f32 v27, v27
    v_exp_f32 v28, v28
    v_exp_f32 v29, v29
    v_exp_f32 v30, v30
    v_exp_f32 v31, v31
    v_cvt_pk_bf16_f32 v120, v24, v25
    v_cvt_pk_bf16_f32 v121, v26, v27
    v_cvt_pk_bf16_f32 v122, v28, v29
    v_cvt_pk_bf16_f32 v123, v30, v31
    v_exp_f32 v32, v32
    v_exp_f32 v33, v33
    v_exp_f32 v34, v34
    s_waitcnt lgkmcnt(2)
    v_mfma_f32_32x32x16_bf16 v[88:103], v[140:143], v[120:123], v[88:103]
    v_exp_f32 v35, v35
    v_exp_f32 v36, v36
    v_exp_f32 v37, v37
    v_exp_f32 v38, v38
    v_exp_f32 v39, v39
    v_cvt_pk_bf16_f32 v124, v32, v33
    v_cvt_pk_bf16_f32 v125, v34, v35
    v_cvt_pk_bf16_f32 v126, v36, v37
    v_cvt_pk_bf16_f32 v127, v38, v39
    s_waitcnt lgkmcnt(0)
    v_exp_f32 v40, v40
    v_exp_f32 v41, v41
    v_mfma_f32_32x32x16_bf16 v[24:39], v[136:139], v[10:13], v[56:71]
    v_exp_f32 v42, v42
    v_exp_f32 v43, v43
    v_exp_f32 v44, v44
    v_mfma_f32_32x32x16_bf16 v[88:103], v[144:147], v[124:127], v[88:103]
    v_exp_f32 v45, v45
    v_exp_f32 v46, v46
    v_exp_f32 v47, v47
    v_cvt_pk_bf16_f32 v128, v40, v41
    v_cvt_pk_bf16_f32 v129, v42, v43
    v_cvt_pk_bf16_f32 v130, v44, v45
    v_cvt_pk_bf16_f32 v131, v46, v47
    v_exp_f32 v48, v48
    v_exp_f32 v49, v49
    v_exp_f32 v50, v50
    v_mfma_f32_32x32x16_bf16 v[104:119], v[140:143], v[128:131], v[104:119]
    ds_read_b128 v[140:143], v19 offset:3072
    v_exp_f32 v51, v51
    v_exp_f32 v52, v52
    v_exp_f32 v53, v53
    v_exp_f32 v54, v54
    v_exp_f32 v55, v55
    v_cvt_pk_bf16_f32 v132, v48, v49
    v_cvt_pk_bf16_f32 v133, v50, v51
    v_cvt_pk_bf16_f32 v134, v52, v53
    v_cvt_pk_bf16_f32 v135, v54, v55
    v_mfma_f32_32x32x16_bf16 v[40:55], v[136:139], v[14:17], v[72:87]
    v_exp_f32 v24, v24
    v_exp_f32 v25, v25
    v_exp_f32 v26, v26
    v_mfma_f32_32x32x16_bf16 v[104:119], v[144:147], v[132:135], v[104:119]
    ds_read_b128 v[144:147], v19 offset:3584
    ds_read_b128 v[136:139], v18 offset:32768
    v_exp_f32 v27, v27
    v_exp_f32 v28, v28
    v_exp_f32 v29, v29
    v_exp_f32 v30, v30
    v_exp_f32 v31, v31
    v_cvt_pk_bf16_f32 v120, v24, v25
    v_cvt_pk_bf16_f32 v121, v26, v27
    v_cvt_pk_bf16_f32 v122, v28, v29
    v_cvt_pk_bf16_f32 v123, v30, v31
    v_exp_f32 v32, v32
    v_exp_f32 v33, v33
    v_exp_f32 v34, v34
    s_waitcnt lgkmcnt(2)
    v_mfma_f32_32x32x16_bf16 v[88:103], v[140:143], v[120:123], v[88:103]
    v_exp_f32 v35, v35
    v_exp_f32 v36, v36
    v_exp_f32 v37, v37
    v_exp_f32 v38, v38
    v_exp_f32 v39, v39
    v_cvt_pk_bf16_f32 v124, v32, v33
    v_cvt_pk_bf16_f32 v125, v34, v35
    v_cvt_pk_bf16_f32 v126, v36, v37
    v_cvt_pk_bf16_f32 v127, v38, v39
    s_waitcnt lgkmcnt(0)
    v_exp_f32 v40, v40
    v_exp_f32 v41, v41
    v_mfma_f32_32x32x16_bf16 v[24:39], v[136:139], v[10:13], v[56:71]
    v_exp_f32 v42, v42
    v_exp_f32 v43, v43
    v_exp_f32 v44, v44
    v_mfma_f32_32x32x16_bf16 v[88:103], v[144:147], v[124:127], v[88:103]
    v_exp_f32 v45, v45
    v_exp_f32 v46, v46
    v_exp_f32 v47, v47
    v_cvt_pk_bf16_f32 v128, v40, v41
    v_cvt_pk_bf16_f32 v129, v42, v43
    v_cvt_pk_bf16_f32 v130, v44, v45
    v_cvt_pk_bf16_f32 v131, v46, v47
    v_exp_f32 v48, v48
    v_exp_f32 v49, v49
    v_exp_f32 v50, v50
    v_mfma_f32_32x32x16_bf16 v[104:119], v[140:143], v[128:131], v[104:119]
    v_add_u32 v19, v19, v20
    ds_read_b128 v[140:143], v19
    v_exp_f32 v51, v51
    v_exp_f32 v52, v52
    v_exp_f32 v53, v53
    v_exp_f32 v54, v54
    v_exp_f32 v55, v55
    v_cvt_pk_bf16_f32 v132, v48, v49
    v_cvt_pk_bf16_f32 v133, v50, v51
    v_cvt_pk_bf16_f32 v134, v52, v53
    v_cvt_pk_bf16_f32 v135, v54, v55
    s_setprio 0
    s_nop 0
    v_mfma_f32_32x32x16_bf16 v[104:119], v[144:147], v[132:135], v[104:119]
    s_mul_i32 s42, s36, 2304
    s_add_u32 s42, s42, 135168
    v_add_u32 v6, s42, v4
    s_xor_b32 s43, s36, 4
    s_mul_i32 s43, s43, 2304
    s_add_u32 s43, s43, 135168
    v_add_u32 v7, s43, v4
    v_lshlrev_b32 v8, 2, v1
    v_add_u32 v9, s43, v8
    v_add_u32 v8, s42, v8
    s_waitcnt vmcnt(0)
    v_cmp_ne_u32 vcc, s41, v21
    ds_write_b128 v6, v[104:107]
    ds_write_b128 v6, v[108:111] offset:1024
    ds_write_b32 v8, v112 offset:2048
    s_cmp_eq_u64 vcc, 0
    s_cselect_b32 s41, 1, 0
    s_waitcnt lgkmcnt(0)
    s_barrier
    ds_read_b32 v32, v9 offset:2048
    ds_read_b128 v[24:27], v7
    ds_read_b128 v[28:31], v7 offset:1024
    s_mov_b32 s42, 0x53800000
    s_waitcnt lgkmcnt(0)
    v_add_f32 v96, v96, v32
    v_add_f32 v88, v88, v24
    v_add_f32 v89, v89, v25
    v_add_f32 v90, v90, v26
    v_add_f32 v91, v91, v27
    v_add_f32 v92, v92, v28
    v_add_f32 v93, v93, v29
    v_add_f32 v94, v94, v30
    v_add_f32 v95, v95, v31
    v_cmp_nlt_f32 vcc, v96, s42
    s_mov_b32 s43, 0x2b800000
    s_cbranch_vccnz block_kernel_slow
    v_cmp_ngt_f32 vcc, v96, s43
    s_nop 0
    s_cbranch_vccnz block_kernel_slow
block_kernel_fin:
    v_rcp_f32 v6, v96
    s_lshl_b32 s42, s46, 15
    s_lshl_b32 s43, s2, 10
    s_add_u32 s42, s42, s43
    v_mul_f32 v88, v88, v6
    v_mul_f32 v89, v89, v6
    v_mul_f32 v90, v90, v6
    v_mul_f32 v91, v91, v6
    v_mul_f32 v92, v92, v6
    v_mul_f32 v93, v93, v6
    v_mul_f32 v94, v94, v6
    v_mul_f32 v95, v95, v6
    v_cvt_pk_bf16_f32 v120, v88, v89
    v_cvt_pk_bf16_f32 v121, v90, v91
    v_cvt_pk_bf16_f32 v122, v92, v93
    v_cvt_pk_bf16_f32 v123, v94, v95
    s_cmp_eq_u32 s41, 0
    s_cbranch_scc1 block_kernel_st18
    buffer_store_dwordx4 v[120:123], v4, s[20:23], s42 offen
    s_branch block_kernel_st19
block_kernel_st18:
    buffer_store_dwordx4 v[120:123], v4, s[20:23], s42 offen sc1
block_kernel_st19:
    s_lshl_b32 s47, s37, 8
    s_lshl_b32 s42, s2, 3
    s_add_u32 s47, s47, s42
    s_lshl_b32 s42, s38, 2
    s_add_u32 s47, s47, s42
    s_add_u32 s47, s47, 1024
    s_lshr_b32 s46, s40, 3
    s_lshl_b32 s42, s39, 2
    s_add_u32 s46, s46, s42
    s_and_b32 s48, s40, 7
    v_mov_b32 v6, 0
    v_mov_b32 v7, 1
    s_waitcnt vmcnt(0)
    s_mov_b64 exec, 1
    s_cmp_eq_u32 s41, 0
    s_cbranch_scc1 block_kernel_st20
    buffer_store_dword v7, v6, s[28:31], s47 offen
    s_branch block_kernel_st21
block_kernel_st20:
    buffer_store_dword v7, v6, s[28:31], s47 offen sc1
block_kernel_st21:
    s_mov_b64 exec, -1
    s_lshl_b32 s42, s37, 12
    s_lshl_b32 s43, s38, 15
    s_add_u32 s42, s42, s43
    v_add_u32 v8, s42, v4
    ds_write_b128 v8, a[8:11] offset:0
    ds_write_b128 v8, a[12:15] offset:1024
    ds_write_b128 v8, a[16:19] offset:2048
    ds_write_b128 v8, a[20:23] offset:3072
    ds_write_b128 v8, a[24:27] offset:16384
    ds_write_b128 v8, a[28:31] offset:17408
    ds_write_b128 v8, a[32:35] offset:18432
    ds_write_b128 v8, a[36:39] offset:19456
    s_cmp_eq_u32 s38, 0
    s_cbranch_scc1 block_kernel_comp
    s_and_b32 s44, s37, 1
    v_bfe_u32 v6, v1, 2, 2
    v_lshl_add_u32 v7, v3, 2, v6
    v_lshlrev_b32 v7, 7, v7
    v_lshrrev_b32 v6, 1, v6
    v_xor_b32 v6, s44, v6
    v_lshl_add_u32 v7, v6, 6, v7
    v_bfe_u32 v6, v1, 4, 1
    v_lshl_add_u32 v7, v6, 5, v7
    v_and_b32 v6, 3, v1
    v_lshl_add_u32 v124, v6, 3, v7
    s_lshr_b32 s44, s37, 1
    s_lshl_b32 s44, s44, 16
    v_add_u32 v124, s44, v124
    v_lshrrev_b32 v6, 2, v1
    v_lshrrev_b32 v7, 4, v1
    v_xor_b32 v6, v6, v7
    v_and_b32 v6, 1, v6
    v_add_u32 v6, -1, v6
    v_and_b32 v126, 0x3f803f80, v6
    v_mov_b32 v127, v126
    v_mov_b32 v128, v126
    v_mov_b32 v129, v126
    v_bfe_u32 v6, v1, 4, 1
    v_lshlrev_b32 v6, 2, v6
    v_and_b32 v7, 7, v1
    v_xor_b32 v6, v6, v7
    v_lshlrev_b32 v6, 4, v6
    v_lshrrev_b32 v8, 3, v1
    v_lshl_add_u32 v10, v8, 10, v6
    v_add_u32 v11, 8192, v10
    s_lshl_b32 s32, s37, 14
    s_lshl_b32 s42, s48, 7
    s_add_u32 s32, s32, s42
    s_lshl_b32 s33, s37, 11
    s_lshl_b32 s34, s46, 16
    s_lshr_b32 s42, s37, 1
    s_lshl_b32 s42, s42, 15
    s_and_b32 s43, s37, 1
    s_lshl_b32 s43, s43, 12
    s_add_u32 s35, s42, s43
    s_add_u32 s34, s34, s35
    s_mov_b32 s16, s14
    s_mov_b32 s17, s15
    s_mov_b32 s18, 1835008
    s_mov_b32 s19, 0x20000
    v_add_u32 v146, s33, v4
    v_add_u32 v147, 65536, v146
    v_add_u32 v148, 131072, v146
    s_lshr_b32 s42, s40, 3
    s_lshl_b32 s42, s42, 8
    s_add_u32 s42, s42, 1024
    v_lshlrev_b32 v6, 2, v1
    s_mov_b32 exec_lo, -1
    s_mov_b32 exec_hi, -1
    s_mov_b32 s45, 0
block_kernel_pl22:
    buffer_load_dword v7, v6, s[28:31], s42 offen sc1
    s_add_u32 s45, s45, 1
    s_waitcnt vmcnt(0)
    v_cmp_eq_u32 vcc, 0, v7
    s_cmp_ge_u32 s45, 200000
    s_cbranch_vccz block_kernel_pl23
    s_cbranch_scc0 block_kernel_pl22
block_kernel_pl23:
    s_mov_b64 exec, -1
    s_add_u32 m0, s35, 65536
    s_add_u32 s42, s34, 0
    buffer_load_dwordx4 v4, s[20:23], s42 offen offset:0 sc1 lds
    buffer_load_dwordx4 v4, s[20:23], s42 offen offset:1024 sc1 lds
    buffer_load_dwordx4 v4, s[20:23], s42 offen offset:2048 sc1 lds
    buffer_load_dwordx4 v4, s[20:23], s42 offen offset:3072 sc1 lds
    s_add_u32 m0, s35, 73728
    s_add_u32 s42, s34, 8192
    buffer_load_dwordx4 v4, s[20:23], s42 offen offset:0 sc1 lds
    buffer_load_dwordx4 v4, s[20:23], s42 offen offset:1024 sc1 lds
    buffer_load_dwordx4 v4, s[20:23], s42 offen offset:2048 sc1 lds
    buffer_load_dwordx4 v4, s[20:23], s42 offen offset:3072 sc1 lds
    s_waitcnt vmcnt(4) lgkmcnt(0)
    s_barrier
    s_add_u32 m0, s35, 81920
    s_add_u32 s42, s34, 16384
    buffer_load_dwordx4 v4, s[20:23], s42 offen offset:0 sc1 lds
    buffer_load_dwordx4 v4, s[20:23], s42 offen offset:1024 sc1 lds
    buffer_load_dwordx4 v4, s[20:23], s42 offen offset:2048 sc1 lds
    buffer_load_dwordx4 v4, s[20:23], s42 offen offset:3072 sc1 lds
    s_add_u32 m0, s35, 90112
    s_add_u32 s42, s34, 24576
    buffer_load_dwordx4 v4, s[20:23], s42 offen offset:0 sc1 lds
    buffer_load_dwordx4 v4, s[20:23], s42 offen offset:1024 sc1 lds
    buffer_load_dwordx4 v4, s[20:23], s42 offen offset:2048 sc1 lds
    buffer_load_dwordx4 v4, s[20:23], s42 offen offset:3072 sc1 lds
    s_waitcnt vmcnt(8)
    s_barrier
    s_waitcnt vmcnt(4)
    s_barrier
    s_waitcnt vmcnt(0)
    s_barrier
    s_barrier
    s_cmp_ge_u32 s40, 28
    s_cbranch_scc1 block_kernel_ld24
    s_lshl_b32 s42, s37, 14
    s_xor_b32 s43, s38, 1
    s_lshl_b32 s43, s43, 16
    s_add_u32 s42, s42, s43
    v_add_u32 v9, s42, v4
    ds_write_b128 v9, a[40:43] offset:0
    ds_write_b128 v9, a[44:47] offset:1024
    ds_write_b128 v9, a[48:51] offset:2048
    ds_write_b128 v9, a[52:55] offset:3072
    ds_write_b128 v9, a[56:59] offset:4096
    ds_write_b128 v9, a[60:63] offset:5120
    ds_write_b128 v9, a[64:67] offset:6144
    ds_write_b128 v9, a[68:71] offset:7168
    ds_write_b128 v9, a[72:75] offset:8192
    ds_write_b128 v9, a[76:79] offset:9216
    ds_write_b128 v9, a[80:83] offset:10240
    ds_write_b128 v9, a[84:87] offset:11264
    ds_write_b128 v9, a[88:91] offset:12288
    ds_write_b128 v9, a[92:95] offset:13312
    ds_write_b128 v9, a[96:99] offset:14336
    ds_write_b128 v9, a[100:103] offset:15360
    v_mov_b32 v6, 154112
    v_mov_b32 v7, 1
    s_waitcnt lgkmcnt(0)
    s_mov_b64 exec, 1
    ds_add_u32 v6, v7 offset:0
    s_mov_b64 exec, -1
block_kernel_ld24:
    s_add_u32 s42, s32, 0
    buffer_load_dwordx4 v[12:15], v10, s[16:19], s42 offen
    buffer_load_dwordx4 v[16:19], v11, s[16:19], s42 offen
    s_waitcnt vmcnt(5)
    s_add_u32 s42, s32, 131072
    buffer_load_dwordx4 v[20:23], v10, s[16:19], s42 offen
    buffer_load_dwordx4 v[24:27], v11, s[16:19], s42 offen
    s_waitcnt vmcnt(5)
    s_add_u32 s42, s32, 262144
    buffer_load_dwordx4 v[28:31], v10, s[16:19], s42 offen
    buffer_load_dwordx4 v[32:35], v11, s[16:19], s42 offen
    s_waitcnt vmcnt(5)
    s_add_u32 s42, s32, 393216
    buffer_load_dwordx4 v[36:39], v10, s[16:19], s42 offen
    buffer_load_dwordx4 v[40:43], v11, s[16:19], s42 offen
    s_waitcnt vmcnt(5)
    s_add_u32 s42, s32, 524288
    buffer_load_dwordx4 v[44:47], v10, s[16:19], s42 offen
    buffer_load_dwordx4 v[48:51], v11, s[16:19], s42 offen
    s_waitcnt vmcnt(5)
    s_add_u32 s42, s32, 655360
    buffer_load_dwordx4 v[52:55], v10, s[16:19], s42 offen
    buffer_load_dwordx4 v[56:59], v11, s[16:19], s42 offen
    s_waitcnt vmcnt(5)
    s_add_u32 s42, s32, 786432
    buffer_load_dwordx4 v[60:63], v10, s[16:19], s42 offen
    buffer_load_dwordx4 v[64:67], v11, s[16:19], s42 offen
    s_waitcnt vmcnt(5)
    s_add_u32 s42, s32, 917504
    buffer_load_dwordx4 v[68:71], v10, s[16:19], s42 offen
    buffer_load_dwordx4 v[72:75], v11, s[16:19], s42 offen
    s_waitcnt vmcnt(5)
    s_cmp_ge_u32 s40, 28
    s_cbranch_scc1 block_kernel_ld25
    v_mov_b32 v6, 154112
block_kernel_wc26:
    ds_read_b32 v7, v6 offset:0
    s_waitcnt lgkmcnt(0)
    v_cmp_gt_u32 vcc, 8, v7
    s_cbranch_vccnz block_kernel_wc26
    ds_read_b64_tr_b16 v[130:131], v124 offset:0
    ds_read_b64_tr_b16 v[132:133], v124 offset:1024
    ds_read_b64_tr_b16 v[134:135], v124 offset:2048
    ds_read_b64_tr_b16 v[136:137], v124 offset:3072
    ds_read_b64_tr_b16 v[138:139], v124 offset:4096
    ds_read_b64_tr_b16 v[140:141], v124 offset:5120
    s_waitcnt lgkmcnt(4)
    v_mfma_f32_16x16x32_bf16 v[142:145], v[126:129], v[130:133], 0
    ds_read_b64_tr_b16 v[130:131], v124 offset:6144
    ds_read_b64_tr_b16 v[132:133], v124 offset:7168
    s_waitcnt lgkmcnt(4)
    v_mfma_f32_16x16x32_bf16 v[142:145], v[126:129], v[134:137], v[142:145]
    ds_read_b64_tr_b16 v[134:135], v124 offset:8192
    ds_read_b64_tr_b16 v[136:137], v124 offset:9216
    s_waitcnt lgkmcnt(4)
    v_mfma_f32_16x16x32_bf16 v[142:145], v[126:129], v[138:141], v[142:145]
    ds_read_b64_tr_b16 v[138:139], v124 offset:10240
    ds_read_b64_tr_b16 v[140:141], v124 offset:11264
    s_waitcnt lgkmcnt(4)
    v_mfma_f32_16x16x32_bf16 v[142:145], v[126:129], v[130:133], v[142:145]
    ds_read_b64_tr_b16 v[130:131], v124 offset:12288
    ds_read_b64_tr_b16 v[132:133], v124 offset:13312
    s_waitcnt lgkmcnt(4)
    v_mfma_f32_16x16x32_bf16 v[142:145], v[126:129], v[134:137], v[142:145]
    ds_read_b64_tr_b16 v[134:135], v124 offset:14336
    ds_read_b64_tr_b16 v[136:137], v124 offset:15360
    s_waitcnt lgkmcnt(4)
    v_mfma_f32_16x16x32_bf16 v[142:145], v[126:129], v[138:141], v[142:145]
    ds_read_b64_tr_b16 v[138:139], v124 offset:16384
    ds_read_b64_tr_b16 v[140:141], v124 offset:17408
    s_waitcnt lgkmcnt(4)
    v_mfma_f32_16x16x32_bf16 v[142:145], v[126:129], v[130:133], v[142:145]
    ds_read_b64_tr_b16 v[130:131], v124 offset:18432
    ds_read_b64_tr_b16 v[132:133], v124 offset:19456
    s_waitcnt lgkmcnt(4)
    v_mfma_f32_16x16x32_bf16 v[142:145], v[126:129], v[134:137], v[142:145]
    ds_read_b64_tr_b16 v[134:135], v124 offset:20480
    ds_read_b64_tr_b16 v[136:137], v124 offset:21504
    s_waitcnt lgkmcnt(4)
    v_mfma_f32_16x16x32_bf16 v[142:145], v[126:129], v[138:141], v[142:145]
    ds_read_b64_tr_b16 v[138:139], v124 offset:22528
    ds_read_b64_tr_b16 v[140:141], v124 offset:23552
    s_waitcnt lgkmcnt(4)
    v_mfma_f32_16x16x32_bf16 v[142:145], v[126:129], v[130:133], v[142:145]
    ds_read_b64_tr_b16 v[130:131], v124 offset:24576
    ds_read_b64_tr_b16 v[132:133], v124 offset:25600
    s_waitcnt lgkmcnt(4)
    v_mfma_f32_16x16x32_bf16 v[142:145], v[126:129], v[134:137], v[142:145]
    ds_read_b64_tr_b16 v[134:135], v124 offset:26624
    ds_read_b64_tr_b16 v[136:137], v124 offset:27648
    s_waitcnt lgkmcnt(4)
    v_mfma_f32_16x16x32_bf16 v[142:145], v[126:129], v[138:141], v[142:145]
    ds_read_b64_tr_b16 v[138:139], v124 offset:28672
    ds_read_b64_tr_b16 v[140:141], v124 offset:29696
    s_waitcnt lgkmcnt(4)
    v_mfma_f32_16x16x32_bf16 v[142:145], v[126:129], v[130:133], v[142:145]
    ds_read_b64_tr_b16 v[130:131], v124 offset:30720
    ds_read_b64_tr_b16 v[132:133], v124 offset:31744
    s_waitcnt lgkmcnt(4)
    v_mfma_f32_16x16x32_bf16 v[142:145], v[126:129], v[134:137], v[142:145]
    ds_read_b64_tr_b16 v[134:135], v124 offset:32768
    ds_read_b64_tr_b16 v[136:137], v124 offset:33792
    s_waitcnt lgkmcnt(4)
    v_mfma_f32_16x16x32_bf16 v[142:145], v[126:129], v[138:141], v[142:145]
    ds_read_b64_tr_b16 v[138:139], v124 offset:34816
    ds_read_b64_tr_b16 v[140:141], v124 offset:35840
    s_waitcnt lgkmcnt(4)
    v_mfma_f32_16x16x32_bf16 v[142:145], v[126:129], v[130:133], v[142:145]
    ds_read_b64_tr_b16 v[130:131], v124 offset:36864
    ds_read_b64_tr_b16 v[132:133], v124 offset:37888
    s_waitcnt lgkmcnt(4)
    v_mfma_f32_16x16x32_bf16 v[142:145], v[126:129], v[134:137], v[142:145]
    ds_read_b64_tr_b16 v[134:135], v124 offset:38912
    ds_read_b64_tr_b16 v[136:137], v124 offset:39936
    s_waitcnt lgkmcnt(4)
    v_mfma_f32_16x16x32_bf16 v[142:145], v[126:129], v[138:141], v[142:145]
    ds_read_b64_tr_b16 v[138:139], v124 offset:40960
    ds_read_b64_tr_b16 v[140:141], v124 offset:41984
    s_waitcnt lgkmcnt(4)
    v_mfma_f32_16x16x32_bf16 v[142:145], v[126:129], v[130:133], v[142:145]
    ds_read_b64_tr_b16 v[130:131], v124 offset:43008
    ds_read_b64_tr_b16 v[132:133], v124 offset:44032
    s_waitcnt lgkmcnt(4)
    v_mfma_f32_16x16x32_bf16 v[142:145], v[126:129], v[134:137], v[142:145]
    ds_read_b64_tr_b16 v[134:135], v124 offset:45056
    ds_read_b64_tr_b16 v[136:137], v124 offset:46080
    s_waitcnt lgkmcnt(4)
    v_mfma_f32_16x16x32_bf16 v[142:145], v[126:129], v[138:141], v[142:145]
    ds_read_b64_tr_b16 v[138:139], v124 offset:47104
    ds_read_b64_tr_b16 v[140:141], v124 offset:48128
    s_waitcnt lgkmcnt(4)
    v_mfma_f32_16x16x32_bf16 v[142:145], v[126:129], v[130:133], v[142:145]
    ds_read_b64_tr_b16 v[130:131], v124 offset:49152
    ds_read_b64_tr_b16 v[132:133], v124 offset:50176
    s_waitcnt lgkmcnt(4)
    v_mfma_f32_16x16x32_bf16 v[142:145], v[126:129], v[134:137], v[142:145]
    ds_read_b64_tr_b16 v[134:135], v124 offset:51200
    ds_read_b64_tr_b16 v[136:137], v124 offset:52224
    s_waitcnt lgkmcnt(4)
    v_mfma_f32_16x16x32_bf16 v[142:145], v[126:129], v[138:141], v[142:145]
    ds_read_b64_tr_b16 v[138:139], v124 offset:53248
    ds_read_b64_tr_b16 v[140:141], v124 offset:54272
    s_waitcnt lgkmcnt(4)
    v_mfma_f32_16x16x32_bf16 v[142:145], v[126:129], v[130:133], v[142:145]
    ds_read_b64_tr_b16 v[130:131], v124 offset:55296
    ds_read_b64_tr_b16 v[132:133], v124 offset:56320
    s_waitcnt lgkmcnt(4)
    v_mfma_f32_16x16x32_bf16 v[142:145], v[126:129], v[134:137], v[142:145]
    ds_read_b64_tr_b16 v[134:135], v124 offset:57344
    ds_read_b64_tr_b16 v[136:137], v124 offset:58368
    s_waitcnt lgkmcnt(4)
    v_mfma_f32_16x16x32_bf16 v[142:145], v[126:129], v[138:141], v[142:145]
    ds_read_b64_tr_b16 v[138:139], v124 offset:59392
    ds_read_b64_tr_b16 v[140:141], v124 offset:60416
    s_waitcnt lgkmcnt(4)
    v_mfma_f32_16x16x32_bf16 v[142:145], v[126:129], v[130:133], v[142:145]
    ds_read_b64_tr_b16 v[130:131], v124 offset:61440
    ds_read_b64_tr_b16 v[132:133], v124 offset:62464
    s_waitcnt lgkmcnt(4)
    v_mfma_f32_16x16x32_bf16 v[142:145], v[126:129], v[134:137], v[142:145]
    ds_read_b64_tr_b16 v[134:135], v124 offset:63488
    ds_read_b64_tr_b16 v[136:137], v124 offset:64512
    s_waitcnt lgkmcnt(4)
    v_mfma_f32_16x16x32_bf16 v[142:145], v[126:129], v[138:141], v[142:145]
    s_waitcnt lgkmcnt(2)
    v_mfma_f32_16x16x32_bf16 v[142:145], v[126:129], v[130:133], v[142:145]
    s_waitcnt lgkmcnt(0)
    v_mfma_f32_16x16x32_bf16 v[142:145], v[126:129], v[134:137], v[142:145]
    s_lshl_b32 s42, s37, 7
    s_add_u32 s42, s42, 153600
    v_lshlrev_b32 v6, 2, v2
    v_add_u32 v6, s42, v6
    s_nop 3
    ds_write_b32 v6, v142
    v_mov_b32 v6, 154112
    v_mov_b32 v7, 1
    s_waitcnt lgkmcnt(0)
    s_mov_b64 exec, 1
    ds_add_u32 v6, v7 offset:0
    s_mov_b64 exec, -1
block_kernel_ld25:
    s_add_u32 s42, s32, 1048576
    buffer_load_dwordx4 v[76:79], v10, s[16:19], s42 offen
    buffer_load_dwordx4 v[80:83], v11, s[16:19], s42 offen
    s_waitcnt vmcnt(5)
    s_add_u32 s42, s32, 1179648
    buffer_load_dwordx4 v[84:87], v10, s[16:19], s42 offen
    buffer_load_dwordx4 v[88:91], v11, s[16:19], s42 offen
    s_waitcnt vmcnt(5)
    s_add_u32 s42, s32, 1310720
    buffer_load_dwordx4 v[92:95], v10, s[16:19], s42 offen
    buffer_load_dwordx4 v[96:99], v11, s[16:19], s42 offen
    s_waitcnt vmcnt(5)
    s_add_u32 s42, s32, 1441792
    buffer_load_dwordx4 v[100:103], v10, s[16:19], s42 offen
    buffer_load_dwordx4 v[104:107], v11, s[16:19], s42 offen
    s_waitcnt vmcnt(5)
    s_add_u32 s42, s32, 1572864
    buffer_load_dwordx4 v[108:111], v10, s[16:19], s42 offen
    buffer_load_dwordx4 v[112:115], v11, s[16:19], s42 offen
    s_waitcnt vmcnt(5)
    s_add_u32 s42, s32, 1703936
    buffer_load_dwordx4 v[116:119], v10, s[16:19], s42 offen
    buffer_load_dwordx4 v[120:123], v11, s[16:19], s42 offen
    s_waitcnt vmcnt(5)
    s_cmp_ge_u32 s40, 28
    s_cbranch_scc1 block_kernel_ld27
    v_mov_b32 v6, 154112
block_kernel_wc28:
    ds_read_b32 v7, v6 offset:4
    s_waitcnt lgkmcnt(0)
    v_cmp_gt_u32 vcc, 4, v7
    s_cbranch_vccnz block_kernel_wc28
block_kernel_ld27:
    s_add_u32 s42, s32, 65536
    buffer_load_dwordx4 a[8:11], v10, s[16:19], s42 offen
    buffer_load_dwordx4 a[12:15], v11, s[16:19], s42 offen
    s_waitcnt vmcnt(28)
    ds_write_b128 v148, v[12:15] offset:0
    ds_write_b128 v148, v[16:19] offset:1024
    s_add_u32 s42, s32, 196608
    buffer_load_dwordx4 a[16:19], v10, s[16:19], s42 offen
    buffer_load_dwordx4 a[20:23], v11, s[16:19], s42 offen
    s_waitcnt vmcnt(28)
    ds_write_b128 v148, v[20:23] offset:8192
    ds_write_b128 v148, v[24:27] offset:9216
    s_add_u32 s42, s32, 327680
    buffer_load_dwordx4 a[24:27], v10, s[16:19], s42 offen
    buffer_load_dwordx4 a[28:31], v11, s[16:19], s42 offen
    s_waitcnt vmcnt(28)
    ds_write_b128 v148, v[28:31] offset:24576
    ds_write_b128 v148, v[32:35] offset:25600
    s_add_u32 s42, s32, 458752
    buffer_load_dwordx4 a[32:35], v10, s[16:19], s42 offen
    buffer_load_dwordx4 a[36:39], v11, s[16:19], s42 offen
    s_waitcnt vmcnt(28)
    ds_write_b128 v146, v[36:39] offset:0
    ds_write_b128 v146, v[40:43] offset:1024
    s_add_u32 s42, s32, 589824
    buffer_load_dwordx4 a[40:43], v10, s[16:19], s42 offen
    buffer_load_dwordx4 a[44:47], v11, s[16:19], s42 offen
    s_waitcnt vmcnt(28)
    ds_write_b128 v146, v[44:47] offset:8192
    ds_write_b128 v146, v[48:51] offset:9216
    s_add_u32 s42, s32, 720896
    buffer_load_dwordx4 a[48:51], v10, s[16:19], s42 offen
    buffer_load_dwordx4 a[52:55], v11, s[16:19], s42 offen
    s_waitcnt vmcnt(28)
    ds_write_b128 v146, v[52:55] offset:16384
    ds_write_b128 v146, v[56:59] offset:17408
    s_add_u32 s42, s32, 851968
    buffer_load_dwordx4 a[56:59], v10, s[16:19], s42 offen
    buffer_load_dwordx4 a[60:63], v11, s[16:19], s42 offen
    s_waitcnt vmcnt(28)
    ds_write_b128 v146, v[60:63] offset:24576
    ds_write_b128 v146, v[64:67] offset:25600
    s_add_u32 s42, s32, 983040
    buffer_load_dwordx4 a[64:67], v10, s[16:19], s42 offen
    buffer_load_dwordx4 a[68:71], v11, s[16:19], s42 offen
    s_waitcnt vmcnt(28)
    ds_write_b128 v146, v[68:71] offset:32768
    ds_write_b128 v146, v[72:75] offset:33792
    s_add_u32 s42, s32, 1114112
    buffer_load_dwordx4 a[72:75], v10, s[16:19], s42 offen
    buffer_load_dwordx4 a[76:79], v11, s[16:19], s42 offen
    s_waitcnt vmcnt(28)
    ds_write_b128 v146, v[76:79] offset:40960
    ds_write_b128 v146, v[80:83] offset:41984
    s_add_u32 s42, s32, 1245184
    buffer_load_dwordx4 a[80:83], v10, s[16:19], s42 offen
    buffer_load_dwordx4 a[84:87], v11, s[16:19], s42 offen
    s_waitcnt vmcnt(28)
    ds_write_b128 v146, v[84:87] offset:49152
    ds_write_b128 v146, v[88:91] offset:50176
    s_add_u32 s42, s32, 1376256
    buffer_load_dwordx4 a[88:91], v10, s[16:19], s42 offen
    buffer_load_dwordx4 a[92:95], v11, s[16:19], s42 offen
    s_waitcnt vmcnt(28)
    ds_write_b128 v146, v[92:95] offset:57344
    ds_write_b128 v146, v[96:99] offset:58368
    s_add_u32 s42, s32, 1507328
    buffer_load_dwordx4 a[96:99], v10, s[16:19], s42 offen
    buffer_load_dwordx4 a[100:103], v11, s[16:19], s42 offen
    v_mov_b32 v6, 154112
    v_mov_b32 v7, 1
    s_waitcnt lgkmcnt(0)
    s_mov_b64 exec, 1
    ds_add_u32 v6, v7 offset:12
    s_mov_b64 exec, -1
    s_add_u32 s42, s32, 1638400
    buffer_load_dwordx4 v[12:15], v10, s[16:19], s42 offen
    buffer_load_dwordx4 v[16:19], v11, s[16:19], s42 offen
    s_add_u32 s42, s32, 1769472
    buffer_load_dwordx4 v[20:23], v10, s[16:19], s42 offen
    buffer_load_dwordx4 v[24:27], v11, s[16:19], s42 offen
    v_mov_b32 v6, 154112
block_kernel_wc29:
    ds_read_b32 v7, v6 offset:8
    s_waitcnt lgkmcnt(0)
    v_cmp_gt_u32 vcc, 4, v7
    s_cbranch_vccnz block_kernel_wc29
    s_waitcnt vmcnt(32)
    ds_write_b128 v147, v[100:103] offset:0
    ds_write_b128 v147, v[104:107] offset:1024
    s_waitcnt vmcnt(30)
    ds_write_b128 v147, v[108:111] offset:8192
    ds_write_b128 v147, v[112:115] offset:9216
    s_waitcnt vmcnt(28)
    ds_write_b128 v147, v[116:119] offset:16384
    ds_write_b128 v147, v[120:123] offset:17408
    s_waitcnt vmcnt(26)
    ds_write_b128 v147, a[8:11] offset:24576
    ds_write_b128 v147, a[12:15] offset:25600
    s_waitcnt vmcnt(24)
    ds_write_b128 v147, a[16:19] offset:32768
    ds_write_b128 v147, a[20:23] offset:33792
    s_waitcnt vmcnt(22)
    ds_write_b128 v147, a[24:27] offset:40960
    ds_write_b128 v147, a[28:31] offset:41984
    s_waitcnt vmcnt(20)
    ds_write_b128 v147, a[32:35] offset:49152
    ds_write_b128 v147, a[36:39] offset:50176
    s_waitcnt vmcnt(18)
    ds_write_b128 v147, a[40:43] offset:57344
    ds_write_b128 v147, a[44:47] offset:58368
    s_waitcnt lgkmcnt(0)
    s_barrier
    s_waitcnt vmcnt(16)
    ds_write_b128 v148, a[48:51] offset:16384
    ds_write_b128 v148, a[52:55] offset:17408
    s_waitcnt vmcnt(14)
    ds_write_b128 v148, a[56:59] offset:0
    ds_write_b128 v148, a[60:63] offset:1024
    s_waitcnt vmcnt(12)
    ds_write_b128 v148, a[64:67] offset:8192
    ds_write_b128 v148, a[68:71] offset:9216
    s_waitcnt vmcnt(10)
    ds_write_b128 v148, a[72:75] offset:24576
    ds_write_b128 v148, a[76:79] offset:25600
    s_waitcnt vmcnt(8)
    ds_write_b128 v146, a[80:83] offset:0
    ds_write_b128 v146, a[84:87] offset:1024
    s_waitcnt vmcnt(6)
    ds_write_b128 v146, a[88:91] offset:8192
    ds_write_b128 v146, a[92:95] offset:9216
    s_waitcnt vmcnt(4)
    ds_write_b128 v146, a[96:99] offset:16384
    ds_write_b128 v146, a[100:103] offset:17408
    s_waitcnt vmcnt(2)
    ds_write_b128 v146, v[12:15] offset:24576
    ds_write_b128 v146, v[16:19] offset:25600
    s_waitcnt vmcnt(0)
    ds_write_b128 v146, v[20:23] offset:32768
    ds_write_b128 v146, v[24:27] offset:33792
    s_waitcnt lgkmcnt(0)
    s_barrier
    s_barrier
    s_lshl_b32 s42, s40, 2
    s_add_u32 s42, s42, s37
    s_cmp_lg_u32 s42, 0
    s_cbranch_scc1 block_kernel_wb30
    buffer_wbl2 sc1
block_kernel_wb30:
    s_barrier
    s_branch block_kernel_done
block_kernel_comp:
    s_setprio 3
    s_lshr_b32 s32, s37, 1
    s_and_b32 s33, s37, 1
    s_lshl_b32 s42, s32, 15
    s_add_u32 s42, s42, 65536
    v_add_u32 v11, s42, v4
    v_bfe_u32 v6, v1, 2, 2
    v_lshl_add_u32 v7, v3, 2, v6
    v_lshlrev_b32 v7, 7, v7
    v_lshrrev_b32 v6, 1, v6
    v_xor_b32 v6, s33, v6
    v_lshl_add_u32 v7, v6, 6, v7
    v_bfe_u32 v6, v1, 4, 1
    v_lshl_add_u32 v7, v6, 5, v7
    v_and_b32 v6, 3, v1
    v_lshl_add_u32 v10, v6, 3, v7
    v_bfe_u32 v6, v2, 1, 3
    s_lshl_b32 s42, s33, 2
    v_xor_b32 v6, s42, v6
    v_lshlrev_b32 v7, 7, v2
    v_lshl_add_u32 v7, v3, 3, v7
    s_lshl_b32 s42, s32, 12
    s_add_u32 s42, s42, 155648
    v_add_u32 v7, s42, v7
    v_xor_b32 v8, 0, v6
    v_lshl_add_u32 v12, v8, 4, v7
    v_xor_b32 v8, 1, v6
    v_lshl_add_u32 v13, v8, 4, v7
    v_xor_b32 v8, 2, v6
    v_lshl_add_u32 v14, v8, 4, v7
    v_xor_b32 v8, 3, v6
    v_lshl_add_u32 v15, v8, 4, v7
    s_add_u32 s20, s4, 8388608
    s_addc_u32 s21, s5, 0
    s_mov_b32 s22, 2097152
    s_mov_b32 s23, 0x20000
    s_add_u32 s24, s4, 17825792
    s_addc_u32 s25, s5, 0
    s_mov_b32 s26, 262144
    s_mov_b32 s27, 0x20000
    s_waitcnt lgkmcnt(0)
    s_barrier
    ds_read_b128 v[16:19], v11 offset:0
    ds_read_b64_tr_b16 v[32:33], v10 offset:0
    ds_read_b64_tr_b16 v[34:35], v10 offset:1024
    ds_read_b128 v[20:23], v11 offset:1024
    ds_read_b64_tr_b16 v[36:37], v10 offset:2048
    ds_read_b64_tr_b16 v[38:39], v10 offset:3072
    ds_read_b128 v[24:27], v11 offset:2048
    ds_read_b64_tr_b16 v[40:41], v10 offset:4096
    ds_read_b64_tr_b16 v[42:43], v10 offset:5120
    s_waitcnt lgkmcnt(6)
    v_mfma_f32_32x32x16_bf16 v[48:63], v[32:35], v[16:19], 0
    ds_read_b128 v[28:31], v11 offset:3072
    ds_read_b64_tr_b16 v[44:45], v10 offset:6144
    ds_read_b64_tr_b16 v[46:47], v10 offset:7168
    s_waitcnt lgkmcnt(6)
    v_mfma_f32_32x32x16_bf16 v[48:63], v[36:39], v[20:23], v[48:63]
    ds_read_b128 v[16:19], v11 offset:4096
    ds_read_b64_tr_b16 v[32:33], v10 offset:8192
    ds_read_b64_tr_b16 v[34:35], v10 offset:9216
    s_waitcnt lgkmcnt(6)
    v_mfma_f32_32x32x16_bf16 v[48:63], v[40:43], v[24:27], v[48:63]
    ds_read_b128 v[20:23], v11 offset:5120
    ds_read_b64_tr_b16 v[36:37], v10 offset:10240
    ds_read_b64_tr_b16 v[38:39], v10 offset:11264
    s_waitcnt lgkmcnt(6)
    v_mfma_f32_32x32x16_bf16 v[48:63], v[44:47], v[28:31], v[48:63]
    ds_read_b128 v[24:27], v11 offset:6144
    ds_read_b64_tr_b16 v[40:41], v10 offset:12288
    ds_read_b64_tr_b16 v[42:43], v10 offset:13312
    s_waitcnt lgkmcnt(6)
    v_mfma_f32_32x32x16_bf16 v[48:63], v[32:35], v[16:19], v[48:63]
    ds_read_b128 v[28:31], v11 offset:7168
    ds_read_b64_tr_b16 v[44:45], v10 offset:14336
    ds_read_b64_tr_b16 v[46:47], v10 offset:15360
    s_waitcnt lgkmcnt(6)
    v_mfma_f32_32x32x16_bf16 v[48:63], v[36:39], v[20:23], v[48:63]
    s_waitcnt lgkmcnt(0)
    s_barrier
    ds_read_b128 v[16:19], v11 offset:8192
    ds_read_b64_tr_b16 v[32:33], v10 offset:16384
    ds_read_b64_tr_b16 v[34:35], v10 offset:17408
    v_mfma_f32_32x32x16_bf16 v[48:63], v[40:43], v[24:27], v[48:63]
    ds_read_b128 v[20:23], v11 offset:9216
    ds_read_b64_tr_b16 v[36:37], v10 offset:18432
    ds_read_b64_tr_b16 v[38:39], v10 offset:19456
    v_mfma_f32_32x32x16_bf16 v[48:63], v[44:47], v[28:31], v[48:63]
    ds_read_b128 v[24:27], v11 offset:10240
    ds_read_b64_tr_b16 v[40:41], v10 offset:20480
    ds_read_b64_tr_b16 v[42:43], v10 offset:21504
    s_waitcnt lgkmcnt(6)
    v_mfma_f32_32x32x16_bf16 v[48:63], v[32:35], v[16:19], v[48:63]
    ds_read_b128 v[28:31], v11 offset:11264
    ds_read_b64_tr_b16 v[44:45], v10 offset:22528
    ds_read_b64_tr_b16 v[46:47], v10 offset:23552
    s_waitcnt lgkmcnt(6)
    v_mfma_f32_32x32x16_bf16 v[48:63], v[36:39], v[20:23], v[48:63]
    ds_read_b128 v[16:19], v11 offset:12288
    ds_read_b64_tr_b16 v[32:33], v10 offset:24576
    ds_read_b64_tr_b16 v[34:35], v10 offset:25600
    s_waitcnt lgkmcnt(6)
    v_mfma_f32_32x32x16_bf16 v[48:63], v[40:43], v[24:27], v[48:63]
    ds_read_b128 v[20:23], v11 offset:13312
    ds_read_b64_tr_b16 v[36:37], v10 offset:26624
    ds_read_b64_tr_b16 v[38:39], v10 offset:27648
    s_waitcnt lgkmcnt(6)
    v_mfma_f32_32x32x16_bf16 v[48:63], v[44:47], v[28:31], v[48:63]
    ds_read_b128 v[24:27], v11 offset:14336
    ds_read_b64_tr_b16 v[40:41], v10 offset:28672
    ds_read_b64_tr_b16 v[42:43], v10 offset:29696
    s_waitcnt lgkmcnt(6)
    v_mfma_f32_32x32x16_bf16 v[48:63], v[32:35], v[16:19], v[48:63]
    ds_read_b128 v[28:31], v11 offset:15360
    ds_read_b64_tr_b16 v[44:45], v10 offset:30720
    ds_read_b64_tr_b16 v[46:47], v10 offset:31744
    s_waitcnt lgkmcnt(6)
    v_mfma_f32_32x32x16_bf16 v[48:63], v[36:39], v[20:23], v[48:63]
    s_waitcnt lgkmcnt(0)
    s_barrier
    ds_read_b128 v[16:19], v11 offset:16384
    ds_read_b64_tr_b16 v[32:33], v10 offset:32768
    ds_read_b64_tr_b16 v[34:35], v10 offset:33792
    v_mfma_f32_32x32x16_bf16 v[48:63], v[40:43], v[24:27], v[48:63]
    ds_read_b128 v[20:23], v11 offset:17408
    ds_read_b64_tr_b16 v[36:37], v10 offset:34816
    ds_read_b64_tr_b16 v[38:39], v10 offset:35840
    v_mfma_f32_32x32x16_bf16 v[48:63], v[44:47], v[28:31], v[48:63]
    ds_read_b128 v[24:27], v11 offset:18432
    ds_read_b64_tr_b16 v[40:41], v10 offset:36864
    ds_read_b64_tr_b16 v[42:43], v10 offset:37888
    s_waitcnt lgkmcnt(6)
    v_mfma_f32_32x32x16_bf16 v[48:63], v[32:35], v[16:19], v[48:63]
    ds_read_b128 v[28:31], v11 offset:19456
    ds_read_b64_tr_b16 v[44:45], v10 offset:38912
    ds_read_b64_tr_b16 v[46:47], v10 offset:39936
    s_waitcnt lgkmcnt(6)
    v_mfma_f32_32x32x16_bf16 v[48:63], v[36:39], v[20:23], v[48:63]
    ds_read_b128 v[16:19], v11 offset:20480
    ds_read_b64_tr_b16 v[32:33], v10 offset:40960
    ds_read_b64_tr_b16 v[34:35], v10 offset:41984
    s_waitcnt lgkmcnt(6)
    v_mfma_f32_32x32x16_bf16 v[48:63], v[40:43], v[24:27], v[48:63]
    ds_read_b128 v[20:23], v11 offset:21504
    ds_read_b64_tr_b16 v[36:37], v10 offset:43008
    ds_read_b64_tr_b16 v[38:39], v10 offset:44032
    s_waitcnt lgkmcnt(6)
    v_mfma_f32_32x32x16_bf16 v[48:63], v[44:47], v[28:31], v[48:63]
    ds_read_b128 v[24:27], v11 offset:22528
    ds_read_b64_tr_b16 v[40:41], v10 offset:45056
    ds_read_b64_tr_b16 v[42:43], v10 offset:46080
    s_waitcnt lgkmcnt(6)
    v_mfma_f32_32x32x16_bf16 v[48:63], v[32:35], v[16:19], v[48:63]
    ds_read_b128 v[28:31], v11 offset:23552
    ds_read_b64_tr_b16 v[44:45], v10 offset:47104
    ds_read_b64_tr_b16 v[46:47], v10 offset:48128
    s_waitcnt lgkmcnt(6)
    v_mfma_f32_32x32x16_bf16 v[48:63], v[36:39], v[20:23], v[48:63]
    s_waitcnt lgkmcnt(0)
    s_barrier
    ds_read_b128 v[16:19], v11 offset:24576
    ds_read_b64_tr_b16 v[32:33], v10 offset:49152
    ds_read_b64_tr_b16 v[34:35], v10 offset:50176
    v_mfma_f32_32x32x16_bf16 v[48:63], v[40:43], v[24:27], v[48:63]
    ds_read_b128 v[20:23], v11 offset:25600
    ds_read_b64_tr_b16 v[36:37], v10 offset:51200
    ds_read_b64_tr_b16 v[38:39], v10 offset:52224
    v_mfma_f32_32x32x16_bf16 v[48:63], v[44:47], v[28:31], v[48:63]
    ds_read_b128 v[24:27], v11 offset:26624
    ds_read_b64_tr_b16 v[40:41], v10 offset:53248
    ds_read_b64_tr_b16 v[42:43], v10 offset:54272
    s_waitcnt lgkmcnt(6)
    v_mfma_f32_32x32x16_bf16 v[48:63], v[32:35], v[16:19], v[48:63]
    ds_read_b128 v[28:31], v11 offset:27648
    ds_read_b64_tr_b16 v[44:45], v10 offset:55296
    ds_read_b64_tr_b16 v[46:47], v10 offset:56320
    s_waitcnt lgkmcnt(6)
    v_mfma_f32_32x32x16_bf16 v[48:63], v[36:39], v[20:23], v[48:63]
    ds_read_b128 v[16:19], v11 offset:28672
    ds_read_b64_tr_b16 v[32:33], v10 offset:57344
    ds_read_b64_tr_b16 v[34:35], v10 offset:58368
    s_waitcnt lgkmcnt(6)
    v_mfma_f32_32x32x16_bf16 v[48:63], v[40:43], v[24:27], v[48:63]
    ds_read_b128 v[20:23], v11 offset:29696
    ds_read_b64_tr_b16 v[36:37], v10 offset:59392
    ds_read_b64_tr_b16 v[38:39], v10 offset:60416
    s_waitcnt lgkmcnt(6)
    v_mfma_f32_32x32x16_bf16 v[48:63], v[44:47], v[28:31], v[48:63]
    ds_read_b128 v[24:27], v11 offset:30720
    ds_read_b64_tr_b16 v[40:41], v10 offset:61440
    ds_read_b64_tr_b16 v[42:43], v10 offset:62464
    s_waitcnt lgkmcnt(6)
    v_mfma_f32_32x32x16_bf16 v[48:63], v[32:35], v[16:19], v[48:63]
    ds_read_b64 v[64:65], v12
    ds_read_b64 v[66:67], v13
    ds_read_b64 v[68:69], v14
    ds_read_b64 v[70:71], v15
    ds_read_b128 v[28:31], v11 offset:31744
    ds_read_b64_tr_b16 v[44:45], v10 offset:63488
    ds_read_b64_tr_b16 v[46:47], v10 offset:64512
    s_waitcnt lgkmcnt(6)
    v_mfma_f32_32x32x16_bf16 v[48:63], v[36:39], v[20:23], v[48:63]
    s_waitcnt lgkmcnt(3)
    v_mfma_f32_32x32x16_bf16 v[48:63], v[40:43], v[24:27], v[48:63]
    s_waitcnt lgkmcnt(0)
    v_mfma_f32_32x32x16_bf16 v[48:63], v[44:47], v[28:31], v[48:63]
    s_barrier
    v_lshlrev_b32 v72, 16, v64
    v_and_b32 v73, 0xffff0000, v64
    v_lshlrev_b32 v74, 16, v65
    v_and_b32 v75, 0xffff0000, v65
    v_lshlrev_b32 v76, 16, v66
    v_and_b32 v77, 0xffff0000, v66
    v_lshlrev_b32 v78, 16, v67
    v_and_b32 v79, 0xffff0000, v67
    v_lshlrev_b32 v80, 16, v68
    v_and_b32 v81, 0xffff0000, v68
    v_lshlrev_b32 v82, 16, v69
    v_and_b32 v83, 0xffff0000, v69
    v_lshlrev_b32 v84, 16, v70
    v_and_b32 v85, 0xffff0000, v70
    v_lshlrev_b32 v86, 16, v71
    v_and_b32 v87, 0xffff0000, v71
    s_lshl_b32 s42, s46, 1
    s_add_u32 s42, s42, s32
    s_lshl_b32 s44, s42, 12
    s_and_b32 s47, s42, 7
    s_lshl_b32 s47, s47, 6
    s_lshl_b32 s42, s42, 15
    s_lshl_b32 s43, s48, 1
    s_add_u32 s43, s43, s33
    s_lshl_b32 s45, s43, 11
    s_add_u32 s42, s42, s45
    s_lshl_b32 s45, s43, 8
    s_add_u32 s44, s44, s45
    s_lshl_b32 s45, s43, 2
    s_add_u32 s47, s47, s45
    s_add_u32 s47, s47, 2048
    v_pk_add_f32 v[72:73], v[72:73], v[48:49]
    v_pk_add_f32 v[74:75], v[74:75], v[50:51]
    v_pk_add_f32 v[76:77], v[76:77], v[52:53]
    v_pk_add_f32 v[78:79], v[78:79], v[54:55]
    v_pk_add_f32 v[80:81], v[80:81], v[56:57]
    v_pk_add_f32 v[82:83], v[82:83], v[58:59]
    v_pk_add_f32 v[84:85], v[84:85], v[60:61]
    v_pk_add_f32 v[86:87], v[86:87], v[62:63]
    v_cvt_pk_bf16_f32 v88, v72, v73
    v_cvt_pk_bf16_f32 v89, v74, v75
    v_cvt_pk_bf16_f32 v90, v76, v77
    v_cvt_pk_bf16_f32 v91, v78, v79
    v_cvt_pk_bf16_f32 v92, v80, v81
    v_cvt_pk_bf16_f32 v93, v82, v83
    v_cvt_pk_bf16_f32 v94, v84, v85
    v_cvt_pk_bf16_f32 v95, v86, v87
    s_cmp_eq_u32 s41, 0
    s_cbranch_scc1 block_kernel_st31
    buffer_store_dwordx4 v[88:91], v4, s[20:23], s42 offen
    buffer_store_dwordx4 v[92:95], v4, s[20:23], s42 offen offset:1024
    s_branch block_kernel_st32
block_kernel_st31:
    buffer_store_dwordx4 v[88:91], v4, s[20:23], s42 offen sc1
    buffer_store_dwordx4 v[92:95], v4, s[20:23], s42 offen offset:1024 sc1
block_kernel_st32:
    v_pk_mul_f32 v[48:49], v[72:73], v[72:73]
    v_pk_fma_f32 v[48:49], v[74:75], v[74:75], v[48:49]
    v_pk_fma_f32 v[48:49], v[76:77], v[76:77], v[48:49]
    v_pk_fma_f32 v[48:49], v[78:79], v[78:79], v[48:49]
    v_pk_fma_f32 v[48:49], v[80:81], v[80:81], v[48:49]
    v_pk_fma_f32 v[48:49], v[82:83], v[82:83], v[48:49]
    v_pk_fma_f32 v[48:49], v[84:85], v[84:85], v[48:49]
    v_pk_fma_f32 v[48:49], v[86:87], v[86:87], v[48:49]
    v_pk_add_f32 v[72:73], v[72:73], v[74:75]
    v_pk_add_f32 v[72:73], v[72:73], v[76:77]
    v_pk_add_f32 v[72:73], v[72:73], v[78:79]
    v_pk_add_f32 v[72:73], v[72:73], v[80:81]
    v_pk_add_f32 v[72:73], v[72:73], v[82:83]
    v_pk_add_f32 v[72:73], v[72:73], v[84:85]
    v_pk_add_f32 v[72:73], v[72:73], v[86:87]
    v_add_f32 v50, v72, v73
    v_add_f32 v51, v48, v49
    v_mov_b32 v52, v50
    v_mov_b32 v53, v51
    v_lshlrev_b32 v8, 3, v2
    s_nop 0
    v_permlane32_swap_b32 v50, v52
    v_permlane32_swap_b32 v51, v53
    v_accvgpr_write_b32 a0, v88
    v_accvgpr_write_b32 a1, v89
    v_accvgpr_write_b32 a2, v90
    v_accvgpr_write_b32 a3, v91
    v_accvgpr_write_b32 a4, v92
    v_accvgpr_write_b32 a5, v93
    v_accvgpr_write_b32 a6, v94
    v_accvgpr_write_b32 a7, v95
    v_pk_add_f32 v[50:51], v[50:51], v[52:53]
    s_cmp_eq_u32 s41, 0
    s_cbranch_scc1 block_kernel_st33
    buffer_store_dwordx2 v[50:51], v8, s[24:27], s44 offen
    s_branch block_kernel_st34
block_kernel_st33:
    buffer_store_dwordx2 v[50:51], v8, s[24:27], s44 offen sc1
block_kernel_st34:
    s_cmp_ge_u32 s40, 28
    s_cbranch_scc1 block_kernel_w135
    s_lshl_b32 s42, s37, 14
    s_xor_b32 s43, s38, 1
    s_lshl_b32 s43, s43, 16
    s_add_u32 s42, s42, s43
    v_add_u32 v9, s42, v4
    ds_write_b128 v9, a[40:43] offset:0
    ds_write_b128 v9, a[44:47] offset:1024
    ds_write_b128 v9, a[48:51] offset:2048
block_kernel_w135:
    v_mov_b32 v6, 0
    v_mov_b32 v7, 1
    s_waitcnt vmcnt(0)
    s_mov_b64 exec, 1
    s_cmp_eq_u32 s41, 0
    s_cbranch_scc1 block_kernel_st36
    buffer_store_dword v7, v6, s[28:31], s47 offen
    s_branch block_kernel_st37
block_kernel_st36:
    buffer_store_dword v7, v6, s[28:31], s47 offen sc1
block_kernel_st37:
    s_mov_b64 exec, -1
    s_cmp_ge_u32 s40, 28
    s_cbranch_scc1 block_kernel_c5
    ds_write_b128 v9, a[52:55] offset:3072
    ds_write_b128 v9, a[56:59] offset:4096
    ds_write_b128 v9, a[60:63] offset:5120
    ds_write_b128 v9, a[64:67] offset:6144
    ds_write_b128 v9, a[68:71] offset:7168
    ds_write_b128 v9, a[72:75] offset:8192
    ds_write_b128 v9, a[76:79] offset:9216
    ds_write_b128 v9, a[80:83] offset:10240
    ds_write_b128 v9, a[84:87] offset:11264
    ds_write_b128 v9, a[88:91] offset:12288
    ds_write_b128 v9, a[92:95] offset:13312
    ds_write_b128 v9, a[96:99] offset:14336
    ds_write_b128 v9, a[100:103] offset:15360
    s_cmp_ge_u32 s40, 14
    s_cselect_b32 s43, 1, 0
    s_lshl_b32 s34, s43, 2
    s_add_u32 s34, s34, s37
    s_mul_i32 s43, s43, 14
    s_sub_u32 s35, s40, s43
    s_lshl_b32 s42, s33, 6
    v_xor_b32 v11, s42, v10
    v_xor_b32 v12, 64, v11
    v_lshlrev_b32 v14, 3, v2
    v_lshl_add_u32 v14, v3, 11, v14
    s_lshl_b32 s42, s39, 3
    s_add_u32 s42, s42, s34
    s_lshl_b32 s43, s42, 15
    s_add_u32 s43, s43, 8388608
    s_add_u32 s16, s4, s43
    s_addc_u32 s17, s5, 0
    s_mov_b32 s18, 32768
    s_mov_b32 s19, 0x20000
    s_lshl_b32 s43, s42, 12
    s_add_u32 s43, s43, 17825792
    s_add_u32 s24, s4, s43
    s_addc_u32 s25, s5, 0
    s_mov_b32 s26, 4096
    s_mov_b32 s27, 0x20000
    s_mul_i32 s43, s42, 114688
    s_lshl_b32 s44, s35, 13
    s_add_u32 s43, s43, s44
    s_add_u32 s43, s43, 10485760
    s_add_u32 s20, s4, s43
    s_addc_u32 s21, s5, 0
    s_mov_b32 s22, 8192
    s_mov_b32 s23, 0x20000
    s_lshl_b32 s47, s34, 6
    s_lshl_b32 s42, s35, 2
    s_add_u32 s47, s47, s42
    s_add_u32 s47, s47, 3072
    v_mov_b32 v6, 154112
    v_mov_b32 v7, 1
    s_waitcnt lgkmcnt(0)
    s_mov_b64 exec, 1
    ds_add_u32 v6, v7 offset:0
    s_mov_b64 exec, -1
    s_lshl_b32 s42, s34, 6
    s_add_u32 s42, s42, 2048
    v_lshlrev_b32 v6, 2, v1
    s_mov_b32 exec_lo, 65535
    s_mov_b32 exec_hi, 0
    s_mov_b32 s45, 0
block_kernel_pl38:
    buffer_load_dword v7, v6, s[28:31], s42 offen sc1
    s_add_u32 s45, s45, 1
    s_waitcnt vmcnt(0)
    v_cmp_eq_u32 vcc, 0, v7
    s_cmp_ge_u32 s45, 200000
    s_cbranch_vccz block_kernel_pl39
    s_cbranch_scc0 block_kernel_pl38
block_kernel_pl39:
    s_mov_b64 exec, -1
    s_mov_b32 s44, 0
    buffer_load_dwordx4 v[16:19], v4, s[16:19], s44 offen offset:0 sc1
    buffer_load_dwordx4 v[20:23], v4, s[16:19], s44 offen offset:1024 sc1
    buffer_load_dwordx4 v[24:27], v4, s[16:19], s44 offen offset:2048 sc1
    buffer_load_dwordx4 v[28:31], v4, s[16:19], s44 offen offset:3072 sc1
    s_mov_b32 s44, 4096
    buffer_load_dwordx4 v[32:35], v4, s[16:19], s44 offen offset:0 sc1
    buffer_load_dwordx4 v[36:39], v4, s[16:19], s44 offen offset:1024 sc1
    buffer_load_dwordx4 v[40:43], v4, s[16:19], s44 offen offset:2048 sc1
    buffer_load_dwordx4 v[44:47], v4, s[16:19], s44 offen offset:3072 sc1
    s_mov_b32 s44, 8192
    buffer_load_dwordx4 a[8:11], v4, s[16:19], s44 offen offset:0 sc1
    buffer_load_dwordx4 a[12:15], v4, s[16:19], s44 offen offset:1024 sc1
    buffer_load_dwordx4 a[16:19], v4, s[16:19], s44 offen offset:2048 sc1
    buffer_load_dwordx4 a[20:23], v4, s[16:19], s44 offen offset:3072 sc1
    v_mov_b32 v6, 154112
block_kernel_wc40:
    ds_read_b32 v7, v6 offset:0
    s_waitcnt lgkmcnt(0)
    v_cmp_gt_u32 vcc, 8, v7
    s_cbranch_vccnz block_kernel_wc40
    v_lshlrev_b32 v9, 4, v3
    v_add_u32 v9, 153600, v9
    v_lshlrev_b32 v8, 2, v1
    ds_read_b64_tr_b16 v[48:49], v11 offset:0
    ds_read_b64_tr_b16 v[50:51], v11 offset:1024
    ds_read_b64_tr_b16 v[52:53], v12 offset:0
    ds_read_b64_tr_b16 v[54:55], v12 offset:1024
    ds_read_b64_tr_b16 v[56:57], v11 offset:2048
    ds_read_b64_tr_b16 v[58:59], v11 offset:3072
    ds_read_b64_tr_b16 v[60:61], v12 offset:2048
    ds_read_b64_tr_b16 v[62:63], v12 offset:3072
    ds_read_b64_tr_b16 v[64:65], v11 offset:4096
    ds_read_b64_tr_b16 v[66:67], v11 offset:5120
    ds_read_b64_tr_b16 v[68:69], v12 offset:4096
    ds_read_b64_tr_b16 v[70:71], v12 offset:5120
    s_waitcnt vmcnt(11) lgkmcnt(8)
    v_mfma_f32_32x32x16_bf16 v[72:87], v[48:51], v[16:19], 0
    ds_read_b64_tr_b16 v[48:49], v11 offset:6144
    ds_read_b64_tr_b16 v[50:51], v11 offset:7168
    s_mov_b32 s44, 12288
    buffer_load_dwordx4 a[24:27], v4, s[16:19], s44 offen offset:0 sc1
    v_mfma_f32_32x32x16_bf16 v[88:103], v[52:55], v[16:19], 0
    ds_read_b64_tr_b16 v[52:53], v12 offset:6144
    ds_read_b64_tr_b16 v[54:55], v12 offset:7168
    buffer_load_dwordx4 a[28:31], v4, s[16:19], s44 offen offset:1024 sc1
    s_waitcnt vmcnt(12) lgkmcnt(8)
    v_mfma_f32_32x32x16_bf16 v[72:87], v[56:59], v[20:23], v[72:87]
    ds_read_b64_tr_b16 v[56:57], v11 offset:8192
    ds_read_b64_tr_b16 v[58:59], v11 offset:9216
    v_mfma_f32_32x32x16_bf16 v[88:103], v[60:63], v[20:23], v[88:103]
    ds_read_b64_tr_b16 v[60:61], v12 offset:8192
    ds_read_b64_tr_b16 v[62:63], v12 offset:9216
    buffer_load_dwordx4 a[32:35], v4, s[16:19], s44 offen offset:2048 sc1
    s_waitcnt vmcnt(12) lgkmcnt(8)
    v_mfma_f32_32x32x16_bf16 v[72:87], v[64:67], v[24:27], v[72:87]
    ds_read_b64_tr_b16 v[64:65], v11 offset:10240
    ds_read_b64_tr_b16 v[66:67], v11 offset:11264
    buffer_load_dwordx4 a[36:39], v4, s[16:19], s44 offen offset:3072 sc1
    v_mfma_f32_32x32x16_bf16 v[88:103], v[68:71], v[24:27], v[88:103]
    ds_read_b64_tr_b16 v[68:69], v12 offset:10240
    ds_read_b64_tr_b16 v[70:71], v12 offset:11264
    s_mov_b32 s44, 16384
    buffer_load_dwordx4 a[40:43], v4, s[16:19], s44 offen offset:0 sc1
    s_waitcnt vmcnt(13) lgkmcnt(8)
    v_mfma_f32_32x32x16_bf16 v[72:87], v[48:51], v[28:31], v[72:87]
    ds_read_b64_tr_b16 v[48:49], v11 offset:12288
    ds_read_b64_tr_b16 v[50:51], v11 offset:13312
    v_mfma_f32_32x32x16_bf16 v[88:103], v[52:55], v[28:31], v[88:103]
    ds_read_b64_tr_b16 v[52:53], v12 offset:12288
    ds_read_b64_tr_b16 v[54:55], v12 offset:13312
    buffer_load_dwordx4 a[44:47], v4, s[16:19], s44 offen offset:1024 sc1
    s_waitcnt vmcnt(13) lgkmcnt(8)
    v_mfma_f32_32x32x16_bf16 v[72:87], v[56:59], v[32:35], v[72:87]
    ds_read_b64_tr_b16 v[56:57], v11 offset:14336
    ds_read_b64_tr_b16 v[58:59], v11 offset:15360
    buffer_load_dwordx4 a[48:51], v4, s[16:19], s44 offen offset:2048 sc1
    v_mfma_f32_32x32x16_bf16 v[88:103], v[60:63], v[32:35], v[88:103]
    ds_read_b64_tr_b16 v[60:61], v12 offset:14336
    ds_read_b64_tr_b16 v[62:63], v12 offset:15360
    buffer_load_dwordx4 a[52:55], v4, s[16:19], s44 offen offset:3072 sc1
    s_waitcnt vmcnt(14) lgkmcnt(8)
    v_mfma_f32_32x32x16_bf16 v[72:87], v[64:67], v[36:39], v[72:87]
    ds_read_b64_tr_b16 v[64:65], v11 offset:16384
    ds_read_b64_tr_b16 v[66:67], v11 offset:17408
    v_mfma_f32_32x32x16_bf16 v[88:103], v[68:71], v[36:39], v[88:103]
    ds_read_b64_tr_b16 v[68:69], v12 offset:16384
    ds_read_b64_tr_b16 v[70:71], v12 offset:17408
    s_mov_b32 s44, 20480
    buffer_load_dwordx4 a[56:59], v4, s[16:19], s44 offen offset:0 sc1
    s_waitcnt vmcnt(14) lgkmcnt(8)
    v_mfma_f32_32x32x16_bf16 v[72:87], v[48:51], v[40:43], v[72:87]
    ds_read_b64_tr_b16 v[48:49], v11 offset:18432
    ds_read_b64_tr_b16 v[50:51], v11 offset:19456
    buffer_load_dwordx4 a[60:63], v4, s[16:19], s44 offen offset:1024 sc1
    v_mfma_f32_32x32x16_bf16 v[88:103], v[52:55], v[40:43], v[88:103]
    ds_read_b64_tr_b16 v[52:53], v12 offset:18432
    ds_read_b64_tr_b16 v[54:55], v12 offset:19456
    buffer_load_dwordx4 a[64:67], v4, s[16:19], s44 offen offset:2048 sc1
    s_waitcnt vmcnt(15) lgkmcnt(8)
    v_mfma_f32_32x32x16_bf16 v[72:87], v[56:59], v[44:47], v[72:87]
    ds_read_b64_tr_b16 v[56:57], v11 offset:20480
    ds_read_b64_tr_b16 v[58:59], v11 offset:21504
    v_mfma_f32_32x32x16_bf16 v[88:103], v[60:63], v[44:47], v[88:103]
    ds_read_b64_tr_b16 v[60:61], v12 offset:20480
    ds_read_b64_tr_b16 v[62:63], v12 offset:21504
    buffer_load_dwordx4 a[68:71], v4, s[16:19], s44 offen offset:3072 sc1
    s_waitcnt vmcnt(15) lgkmcnt(8)
    v_mfma_f32_32x32x16_bf16 v[72:87], v[64:67], a[8:11], v[72:87]
    ds_read_b64_tr_b16 v[64:65], v11 offset:22528
    ds_read_b64_tr_b16 v[66:67], v11 offset:23552
    s_mov_b32 s44, 24576
    buffer_load_dwordx4 a[72:75], v4, s[16:19], s44 offen offset:0 sc1
    v_mfma_f32_32x32x16_bf16 v[88:103], v[68:71], a[8:11], v[88:103]
    ds_read_b64_tr_b16 v[68:69], v12 offset:22528
    ds_read_b64_tr_b16 v[70:71], v12 offset:23552
    buffer_load_dwordx4 a[76:79], v4, s[16:19], s44 offen offset:1024 sc1
    s_waitcnt vmcnt(16) lgkmcnt(8)
    v_mfma_f32_32x32x16_bf16 v[72:87], v[48:51], a[12:15], v[72:87]
    ds_read_b64_tr_b16 v[48:49], v11 offset:24576
    ds_read_b64_tr_b16 v[50:51], v11 offset:25600
    v_mfma_f32_32x32x16_bf16 v[88:103], v[52:55], a[12:15], v[88:103]
    ds_read_b64_tr_b16 v[52:53], v12 offset:24576
    ds_read_b64_tr_b16 v[54:55], v12 offset:25600
    buffer_load_dwordx4 a[80:83], v4, s[16:19], s44 offen offset:2048 sc1
    s_waitcnt vmcnt(16) lgkmcnt(8)
    v_mfma_f32_32x32x16_bf16 v[72:87], v[56:59], a[16:19], v[72:87]
    ds_read_b64_tr_b16 v[56:57], v11 offset:26624
    ds_read_b64_tr_b16 v[58:59], v11 offset:27648
    buffer_load_dwordx4 a[84:87], v4, s[16:19], s44 offen offset:3072 sc1
    v_mfma_f32_32x32x16_bf16 v[88:103], v[60:63], a[16:19], v[88:103]
    ds_read_b64_tr_b16 v[60:61], v12 offset:26624
    ds_read_b64_tr_b16 v[62:63], v12 offset:27648
    s_mov_b32 s44, 28672
    buffer_load_dwordx4 a[88:91], v4, s[16:19], s44 offen offset:0 sc1
    s_waitcnt vmcnt(17) lgkmcnt(8)
    v_mfma_f32_32x32x16_bf16 v[72:87], v[64:67], a[20:23], v[72:87]
    ds_read_b64_tr_b16 v[64:65], v11 offset:28672
    ds_read_b64_tr_b16 v[66:67], v11 offset:29696
    v_mfma_f32_32x32x16_bf16 v[88:103], v[68:71], a[20:23], v[88:103]
    ds_read_b64_tr_b16 v[68:69], v12 offset:28672
    ds_read_b64_tr_b16 v[70:71], v12 offset:29696
    buffer_load_dwordx4 a[92:95], v4, s[16:19], s44 offen offset:1024 sc1
    s_waitcnt vmcnt(17) lgkmcnt(8)
    v_mfma_f32_32x32x16_bf16 v[72:87], v[48:51], a[24:27], v[72:87]
    ds_read_b64_tr_b16 v[48:49], v11 offset:30720
    ds_read_b64_tr_b16 v[50:51], v11 offset:31744
    buffer_load_dwordx4 a[96:99], v4, s[16:19], s44 offen offset:2048 sc1
    v_mfma_f32_32x32x16_bf16 v[88:103], v[52:55], a[24:27], v[88:103]
    ds_read_b64_tr_b16 v[52:53], v12 offset:30720
    ds_read_b64_tr_b16 v[54:55], v12 offset:31744
    buffer_load_dwordx4 a[100:103], v4, s[16:19], s44 offen offset:3072 sc1
    s_waitcnt vmcnt(18) lgkmcnt(8)
    v_mfma_f32_32x32x16_bf16 v[72:87], v[56:59], a[28:31], v[72:87]
    ds_read_b64_tr_b16 v[56:57], v11 offset:32768
    ds_read_b64_tr_b16 v[58:59], v11 offset:33792
    v_mfma_f32_32x32x16_bf16 v[88:103], v[60:63], a[28:31], v[88:103]
    ds_read_b64_tr_b16 v[60:61], v12 offset:32768
    ds_read_b64_tr_b16 v[62:63], v12 offset:33792
    s_waitcnt vmcnt(17) lgkmcnt(8)
    v_mfma_f32_32x32x16_bf16 v[72:87], v[64:67], a[32:35], v[72:87]
    ds_read_b64_tr_b16 v[64:65], v11 offset:34816
    ds_read_b64_tr_b16 v[66:67], v11 offset:35840
    v_mfma_f32_32x32x16_bf16 v[88:103], v[68:71], a[32:35], v[88:103]
    ds_read_b64_tr_b16 v[68:69], v12 offset:34816
    ds_read_b64_tr_b16 v[70:71], v12 offset:35840
    s_waitcnt vmcnt(16) lgkmcnt(8)
    v_mfma_f32_32x32x16_bf16 v[72:87], v[48:51], a[36:39], v[72:87]
    ds_read_b64_tr_b16 v[48:49], v11 offset:36864
    ds_read_b64_tr_b16 v[50:51], v11 offset:37888
    v_mfma_f32_32x32x16_bf16 v[88:103], v[52:55], a[36:39], v[88:103]
    ds_read_b64_tr_b16 v[52:53], v12 offset:36864
    ds_read_b64_tr_b16 v[54:55], v12 offset:37888
    s_waitcnt vmcnt(15) lgkmcnt(8)
    v_mfma_f32_32x32x16_bf16 v[72:87], v[56:59], a[40:43], v[72:87]
    ds_read_b64_tr_b16 v[56:57], v11 offset:38912
    ds_read_b64_tr_b16 v[58:59], v11 offset:39936
    v_mfma_f32_32x32x16_bf16 v[88:103], v[60:63], a[40:43], v[88:103]
    ds_read_b64_tr_b16 v[60:61], v12 offset:38912
    ds_read_b64_tr_b16 v[62:63], v12 offset:39936
    buffer_load_dword v136, v14, s[24:27], 0 offen offset:0 sc1
    buffer_load_dword v137, v14, s[24:27], 0 offen offset:256 sc1
    buffer_load_dword v138, v14, s[24:27], 0 offen offset:512 sc1
    buffer_load_dword v139, v14, s[24:27], 0 offen offset:768 sc1
    buffer_load_dword v140, v14, s[24:27], 0 offen offset:1024 sc1
    buffer_load_dword v141, v14, s[24:27], 0 offen offset:1280 sc1
    buffer_load_dword v142, v14, s[24:27], 0 offen offset:1536 sc1
    buffer_load_dword v143, v14, s[24:27], 0 offen offset:1792 sc1
    s_waitcnt vmcnt(22) lgkmcnt(8)
    v_mfma_f32_32x32x16_bf16 v[72:87], v[64:67], a[44:47], v[72:87]
    ds_read_b64_tr_b16 v[64:65], v11 offset:40960
    ds_read_b64_tr_b16 v[66:67], v11 offset:41984
    v_mfma_f32_32x32x16_bf16 v[88:103], v[68:71], a[44:47], v[88:103]
    ds_read_b64_tr_b16 v[68:69], v12 offset:40960
    ds_read_b64_tr_b16 v[70:71], v12 offset:41984
    s_waitcnt vmcnt(21) lgkmcnt(8)
    v_mfma_f32_32x32x16_bf16 v[72:87], v[48:51], a[48:51], v[72:87]
    ds_read_b64_tr_b16 v[48:49], v11 offset:43008
    ds_read_b64_tr_b16 v[50:51], v11 offset:44032
    v_mfma_f32_32x32x16_bf16 v[88:103], v[52:55], a[48:51], v[88:103]
    ds_read_b64_tr_b16 v[52:53], v12 offset:43008
    ds_read_b64_tr_b16 v[54:55], v12 offset:44032
    s_waitcnt vmcnt(20) lgkmcnt(8)
    v_mfma_f32_32x32x16_bf16 v[72:87], v[56:59], a[52:55], v[72:87]
    ds_read_b64_tr_b16 v[56:57], v11 offset:45056
    ds_read_b64_tr_b16 v[58:59], v11 offset:46080
    v_mfma_f32_32x32x16_bf16 v[88:103], v[60:63], a[52:55], v[88:103]
    ds_read_b64_tr_b16 v[60:61], v12 offset:45056
    ds_read_b64_tr_b16 v[62:63], v12 offset:46080
    s_waitcnt vmcnt(19) lgkmcnt(8)
    v_mfma_f32_32x32x16_bf16 v[72:87], v[64:67], a[56:59], v[72:87]
    ds_read_b64_tr_b16 v[64:65], v11 offset:47104
    ds_read_b64_tr_b16 v[66:67], v11 offset:48128
    v_mfma_f32_32x32x16_bf16 v[88:103], v[68:71], a[56:59], v[88:103]
    ds_read_b64_tr_b16 v[68:69], v12 offset:47104
    ds_read_b64_tr_b16 v[70:71], v12 offset:48128
    s_waitcnt vmcnt(18) lgkmcnt(8)
    v_mfma_f32_32x32x16_bf16 v[72:87], v[48:51], a[60:63], v[72:87]
    ds_read_b64_tr_b16 v[48:49], v11 offset:49152
    ds_read_b64_tr_b16 v[50:51], v11 offset:50176
    v_mfma_f32_32x32x16_bf16 v[88:103], v[52:55], a[60:63], v[88:103]
    ds_read_b64_tr_b16 v[52:53], v12 offset:49152
    ds_read_b64_tr_b16 v[54:55], v12 offset:50176
    s_waitcnt vmcnt(17) lgkmcnt(8)
    v_mfma_f32_32x32x16_bf16 v[72:87], v[56:59], a[64:67], v[72:87]
    ds_read_b64_tr_b16 v[56:57], v11 offset:51200
    ds_read_b64_tr_b16 v[58:59], v11 offset:52224
    v_mfma_f32_32x32x16_bf16 v[88:103], v[60:63], a[64:67], v[88:103]
    ds_read_b64_tr_b16 v[60:61], v12 offset:51200
    ds_read_b64_tr_b16 v[62:63], v12 offset:52224
    s_waitcnt vmcnt(16) lgkmcnt(8)
    v_mfma_f32_32x32x16_bf16 v[72:87], v[64:67], a[68:71], v[72:87]
    ds_read_b64_tr_b16 v[64:65], v11 offset:53248
    ds_read_b64_tr_b16 v[66:67], v11 offset:54272
    v_mfma_f32_32x32x16_bf16 v[88:103], v[68:71], a[68:71], v[88:103]
    ds_read_b64_tr_b16 v[68:69], v12 offset:53248
    ds_read_b64_tr_b16 v[70:71], v12 offset:54272
    s_waitcnt vmcnt(15) lgkmcnt(8)
    v_mfma_f32_32x32x16_bf16 v[72:87], v[48:51], a[72:75], v[72:87]
    ds_read_b64_tr_b16 v[48:49], v11 offset:55296
    ds_read_b64_tr_b16 v[50:51], v11 offset:56320
    v_mfma_f32_32x32x16_bf16 v[88:103], v[52:55], a[72:75], v[88:103]
    ds_read_b64_tr_b16 v[52:53], v12 offset:55296
    ds_read_b64_tr_b16 v[54:55], v12 offset:56320
    s_waitcnt vmcnt(14) lgkmcnt(8)
    v_mfma_f32_32x32x16_bf16 v[72:87], v[56:59], a[76:79], v[72:87]
    ds_read_b64_tr_b16 v[56:57], v11 offset:57344
    ds_read_b64_tr_b16 v[58:59], v11 offset:58368
    v_mfma_f32_32x32x16_bf16 v[88:103], v[60:63], a[76:79], v[88:103]
    ds_read_b64_tr_b16 v[60:61], v12 offset:57344
    ds_read_b64_tr_b16 v[62:63], v12 offset:58368
    s_waitcnt vmcnt(13) lgkmcnt(8)
    v_mfma_f32_32x32x16_bf16 v[72:87], v[64:67], a[80:83], v[72:87]
    ds_read_b64_tr_b16 v[64:65], v11 offset:59392
    ds_read_b64_tr_b16 v[66:67], v11 offset:60416
    v_mfma_f32_32x32x16_bf16 v[88:103], v[68:71], a[80:83], v[88:103]
    ds_read_b64_tr_b16 v[68:69], v12 offset:59392
    ds_read_b64_tr_b16 v[70:71], v12 offset:60416
    s_waitcnt vmcnt(12) lgkmcnt(8)
    v_mfma_f32_32x32x16_bf16 v[72:87], v[48:51], a[84:87], v[72:87]
    ds_read_b64_tr_b16 v[48:49], v11 offset:61440
    ds_read_b64_tr_b16 v[50:51], v11 offset:62464
    v_mfma_f32_32x32x16_bf16 v[88:103], v[52:55], a[84:87], v[88:103]
    ds_read_b64_tr_b16 v[52:53], v12 offset:61440
    ds_read_b64_tr_b16 v[54:55], v12 offset:62464
    s_waitcnt vmcnt(0)
    v_add_f32 v136, v136, v140
    v_add_f32 v137, v137, v141
    v_add_f32 v138, v138, v142
    v_add_f32 v139, v139, v143
    s_waitcnt lgkmcnt(8)
    v_mfma_f32_32x32x16_bf16 v[72:87], v[56:59], a[88:91], v[72:87]
    ds_read_b64_tr_b16 v[56:57], v11 offset:63488
    ds_read_b64_tr_b16 v[58:59], v11 offset:64512
    v_mfma_f32_32x32x16_bf16 v[88:103], v[60:63], a[88:91], v[88:103]
    ds_read_b64_tr_b16 v[60:61], v12 offset:63488
    ds_read_b64_tr_b16 v[62:63], v12 offset:64512
    v_add_f32 v136, v136, v138
    v_add_f32 v137, v137, v139
    v_add_f32 v136, v136, v137
    s_waitcnt lgkmcnt(8)
    v_mfma_f32_32x32x16_bf16 v[72:87], v[64:67], a[92:95], v[72:87]
    v_add_u32 v11, 65536, v11
    ds_read_b64_tr_b16 v[64:65], v11 offset:0
    ds_read_b64_tr_b16 v[66:67], v11 offset:1024
    v_mfma_f32_32x32x16_bf16 v[88:103], v[68:71], a[92:95], v[88:103]
    v_add_u32 v12, 65536, v12
    ds_read_b64_tr_b16 v[68:69], v12 offset:0
    ds_read_b64_tr_b16 v[70:71], v12 offset:1024
    v_mov_b32 v138, v136
    s_nop 1
    v_permlane32_swap_b32 v136, v138
    s_nop 1
    v_add_f32 v136, v136, v138
    s_waitcnt lgkmcnt(8)
    v_mfma_f32_32x32x16_bf16 v[72:87], v[48:51], a[96:99], v[72:87]
    ds_read_b64_tr_b16 v[48:49], v11 offset:2048
    ds_read_b64_tr_b16 v[50:51], v11 offset:3072
    v_mfma_f32_32x32x16_bf16 v[88:103], v[52:55], a[96:99], v[88:103]
    ds_read_b64_tr_b16 v[52:53], v12 offset:2048
    ds_read_b64_tr_b16 v[54:55], v12 offset:3072
    v_mul_f32 v14, 0xbb000000, v136
    v_cvt_pk_bf16_f32 v14, v14, v14
    v_and_b32 v14, 0xffff0000, v14
    s_waitcnt lgkmcnt(8)
    v_mfma_f32_32x32x16_bf16 v[72:87], v[56:59], a[100:103], v[72:87]
    ds_read_b64_tr_b16 v[56:57], v11 offset:4096
    ds_read_b64_tr_b16 v[58:59], v11 offset:5120
    v_mfma_f32_32x32x16_bf16 v[88:103], v[60:63], a[100:103], v[88:103]
    ds_read_b64_tr_b16 v[60:61], v12 offset:4096
    ds_read_b64_tr_b16 v[62:63], v12 offset:5120
    s_waitcnt lgkmcnt(8)
    v_mfma_f32_32x32x16_bf16 v[104:119], v[64:67], v[16:19], 0
    v_mov_b32 v6, 154112
    v_mov_b32 v7, 1
    s_mov_b64 exec, 1
    ds_add_u32 v6, v7 offset:4
    s_mov_b64 exec, -1
    ds_read_b32 v7, v6
    ds_read_b64_tr_b16 v[64:65], v11 offset:6144
    ds_read_b64_tr_b16 v[66:67], v11 offset:7168
    v_mfma_f32_32x32x16_bf16 v[120:135], v[68:71], v[16:19], 0
    ds_read_b64_tr_b16 v[68:69], v12 offset:6144
    ds_read_b64_tr_b16 v[70:71], v12 offset:7168
    s_waitcnt lgkmcnt(10)
    v_mfma_f32_32x32x16_bf16 v[104:119], v[48:51], v[20:23], v[104:119]
    ds_read_b64_tr_b16 v[48:49], v11 offset:8192
    ds_read_b64_tr_b16 v[50:51], v11 offset:9216
    v_mfma_f32_32x32x16_bf16 v[120:135], v[52:55], v[20:23], v[120:135]
    ds_read_b64_tr_b16 v[52:53], v12 offset:8192
    ds_read_b64_tr_b16 v[54:55], v12 offset:9216
    s_waitcnt lgkmcnt(8)
    v_cmp_gt_u32 vcc, 12, v7
    s_cbranch_vccz block_kernel_cw41
    v_mov_b32 v6, 154112
block_kernel_wc42:
    ds_read_b32 v7, v6 offset:0
    s_waitcnt lgkmcnt(0)
    v_cmp_gt_u32 vcc, 12, v7
    s_cbranch_vccnz block_kernel_wc42
block_kernel_cw41:
    ds_read_b128 v[136:139], v9 offset:0
    ds_read_b128 v[140:143], v9 offset:32
    ds_read_b128 v[144:147], v9 offset:64
    ds_read_b128 v[148:151], v9 offset:96
    v_mfma_f32_32x32x16_bf16 v[104:119], v[56:59], v[24:27], v[104:119]
    ds_read_b64_tr_b16 v[56:57], v11 offset:10240
    ds_read_b64_tr_b16 v[58:59], v11 offset:11264
    v_mfma_f32_32x32x16_bf16 v[120:135], v[60:63], v[24:27], v[120:135]
    ds_read_b64_tr_b16 v[60:61], v12 offset:10240
    ds_read_b64_tr_b16 v[62:63], v12 offset:11264
    s_waitcnt lgkmcnt(12)
    v_mfma_f32_32x32x16_bf16 v[104:119], v[64:67], v[28:31], v[104:119]
    ds_read_b64_tr_b16 v[64:65], v11 offset:12288
    ds_read_b64_tr_b16 v[66:67], v11 offset:13312
    s_waitcnt lgkmcnt(6)
    v_fma_f32 v72, v136, v14, v72
    v_fma_f32 v73, v137, v14, v73
    v_mfma_f32_32x32x16_bf16 v[120:135], v[68:71], v[28:31], v[120:135]
    ds_read_b64_tr_b16 v[68:69], v12 offset:12288
    ds_read_b64_tr_b16 v[70:71], v12 offset:13312
    v_fma_f32 v74, v138, v14, v74
    v_fma_f32 v75, v139, v14, v75
    v_fma_f32 v76, v140, v14, v76
    v_mfma_f32_32x32x16_bf16 v[104:119], v[48:51], v[32:35], v[104:119]
    ds_read_b64_tr_b16 v[48:49], v11 offset:14336
    ds_read_b64_tr_b16 v[50:51], v11 offset:15360
    v_fma_f32 v77, v141, v14, v77
    v_fma_f32 v78, v142, v14, v78
    v_fma_f32 v79, v143, v14, v79
    v_mfma_f32_32x32x16_bf16 v[120:135], v[52:55], v[32:35], v[120:135]
    ds_read_b64_tr_b16 v[52:53], v12 offset:14336
    ds_read_b64_tr_b16 v[54:55], v12 offset:15360
    v_fma_f32 v80, v144, v14, v80
    v_fma_f32 v81, v145, v14, v81
    v_fma_f32 v82, v146, v14, v82
    ds_read_b128 v[16:19], v9 offset:128
    ds_read_b128 v[20:23], v9 offset:160
    ds_read_b128 v[24:27], v9 offset:192
    ds_read_b128 v[28:31], v9 offset:224
    s_waitcnt lgkmcnt(12)
    v_mfma_f32_32x32x16_bf16 v[104:119], v[56:59], v[36:39], v[104:119]
    ds_read_b64_tr_b16 v[56:57], v11 offset:16384
    ds_read_b64_tr_b16 v[58:59], v11 offset:17408
    v_fma_f32 v83, v147, v14, v83
    v_fma_f32 v84, v148, v14, v84
    v_fma_f32 v85, v149, v14, v85
    v_mfma_f32_32x32x16_bf16 v[120:135], v[60:63], v[36:39], v[120:135]
    ds_read_b64_tr_b16 v[60:61], v12 offset:16384
    ds_read_b64_tr_b16 v[62:63], v12 offset:17408
    v_fma_f32 v86, v150, v14, v86
    v_fma_f32 v87, v151, v14, v87
    v_cvt_pk_bf16_f32 v72, v72, v73
    s_waitcnt lgkmcnt(12)
    v_mfma_f32_32x32x16_bf16 v[104:119], v[64:67], v[40:43], v[104:119]
    ds_read_b64_tr_b16 v[64:65], v11 offset:18432
    ds_read_b64_tr_b16 v[66:67], v11 offset:19456
    v_cvt_pk_bf16_f32 v73, v74, v75
    v_cvt_pk_bf16_f32 v74, v76, v77
    v_cvt_pk_bf16_f32 v75, v78, v79
    v_mfma_f32_32x32x16_bf16 v[120:135], v[68:71], v[40:43], v[120:135]
    ds_read_b64_tr_b16 v[68:69], v12 offset:18432
    ds_read_b64_tr_b16 v[70:71], v12 offset:19456
    v_cvt_pk_bf16_f32 v76, v80, v81
    v_cvt_pk_bf16_f32 v77, v82, v83
    v_cvt_pk_bf16_f32 v78, v84, v85
    s_waitcnt lgkmcnt(12)
    v_mfma_f32_32x32x16_bf16 v[104:119], v[48:51], v[44:47], v[104:119]
    ds_read_b64_tr_b16 v[48:49], v11 offset:20480
    ds_read_b64_tr_b16 v[50:51], v11 offset:21504
    v_cvt_pk_bf16_f32 v79, v86, v87
    v_pk_max_i16 v72, v72, 0
    v_pk_max_i16 v73, v73, 0
    v_mfma_f32_32x32x16_bf16 v[120:135], v[52:55], v[44:47], v[120:135]
    ds_read_b64_tr_b16 v[52:53], v12 offset:20480
    ds_read_b64_tr_b16 v[54:55], v12 offset:21504
    v_pk_max_i16 v74, v74, 0
    v_pk_max_i16 v75, v75, 0
    v_pk_max_i16 v76, v76, 0
    s_waitcnt lgkmcnt(8)
    v_mfma_f32_32x32x16_bf16 v[104:119], v[56:59], a[8:11], v[104:119]
    ds_read_b64_tr_b16 v[56:57], v11 offset:22528
    ds_read_b64_tr_b16 v[58:59], v11 offset:23552
    v_pk_max_i16 v77, v77, 0
    v_pk_max_i16 v78, v78, 0
    v_pk_max_i16 v79, v79, 0
    v_mfma_f32_32x32x16_bf16 v[120:135], v[60:63], a[8:11], v[120:135]
    ds_read_b64_tr_b16 v[60:61], v12 offset:22528
    ds_read_b64_tr_b16 v[62:63], v12 offset:23552
    s_cmp_eq_u32 s41, 0
    s_cbranch_scc1 block_kernel_st43
    buffer_store_dwordx4 v[72:75], v4, s[20:23], 0 offen offset:0
    buffer_store_dwordx4 v[76:79], v4, s[20:23], 0 offen offset:1024
    s_branch block_kernel_st44
block_kernel_st43:
    buffer_store_dwordx4 v[72:75], v4, s[20:23], 0 offen offset:0 sc1
    buffer_store_dwordx4 v[76:79], v4, s[20:23], 0 offen offset:1024 sc1
block_kernel_st44:
    v_fma_f32 v88, v16, v14, v88
    s_waitcnt lgkmcnt(8)
    v_mfma_f32_32x32x16_bf16 v[104:119], v[64:67], a[12:15], v[104:119]
    ds_read_b64_tr_b16 v[64:65], v11 offset:24576
    ds_read_b64_tr_b16 v[66:67], v11 offset:25600
    v_fma_f32 v89, v17, v14, v89
    v_fma_f32 v90, v18, v14, v90
    v_fma_f32 v91, v19, v14, v91
    v_mfma_f32_32x32x16_bf16 v[120:135], v[68:71], a[12:15], v[120:135]
    ds_read_b64_tr_b16 v[68:69], v12 offset:24576
    ds_read_b64_tr_b16 v[70:71], v12 offset:25600
    v_fma_f32 v92, v20, v14, v92
    v_fma_f32 v93, v21, v14, v93
    v_fma_f32 v94, v22, v14, v94
    s_waitcnt lgkmcnt(8)
    v_mfma_f32_32x32x16_bf16 v[104:119], v[48:51], a[16:19], v[104:119]
    ds_read_b64_tr_b16 v[48:49], v11 offset:26624
    ds_read_b64_tr_b16 v[50:51], v11 offset:27648
    v_fma_f32 v95, v23, v14, v95
    v_fma_f32 v96, v24, v14, v96
    v_fma_f32 v97, v25, v14, v97
    v_mfma_f32_32x32x16_bf16 v[120:135], v[52:55], a[16:19], v[120:135]
    ds_read_b64_tr_b16 v[52:53], v12 offset:26624
    ds_read_b64_tr_b16 v[54:55], v12 offset:27648
    v_fma_f32 v98, v26, v14, v98
    v_fma_f32 v99, v27, v14, v99
    v_fma_f32 v100, v28, v14, v100
    s_waitcnt lgkmcnt(8)
    v_mfma_f32_32x32x16_bf16 v[104:119], v[56:59], a[20:23], v[104:119]
    ds_read_b64_tr_b16 v[56:57], v11 offset:28672
    ds_read_b64_tr_b16 v[58:59], v11 offset:29696
    v_fma_f32 v101, v29, v14, v101
    v_fma_f32 v102, v30, v14, v102
    v_fma_f32 v103, v31, v14, v103
    v_mfma_f32_32x32x16_bf16 v[120:135], v[60:63], a[20:23], v[120:135]
    ds_read_b64_tr_b16 v[60:61], v12 offset:28672
    ds_read_b64_tr_b16 v[62:63], v12 offset:29696
    v_cvt_pk_bf16_f32 v88, v88, v89
    v_cvt_pk_bf16_f32 v89, v90, v91
    v_cvt_pk_bf16_f32 v90, v92, v93
    s_waitcnt lgkmcnt(8)
    v_mfma_f32_32x32x16_bf16 v[104:119], v[64:67], a[24:27], v[104:119]
    ds_read_b64_tr_b16 v[64:65], v11 offset:30720
    ds_read_b64_tr_b16 v[66:67], v11 offset:31744
    v_cvt_pk_bf16_f32 v91, v94, v95
    v_cvt_pk_bf16_f32 v92, v96, v97
    v_cvt_pk_bf16_f32 v93, v98, v99
    v_mfma_f32_32x32x16_bf16 v[120:135], v[68:71], a[24:27], v[120:135]
    ds_read_b64_tr_b16 v[68:69], v12 offset:30720
    ds_read_b64_tr_b16 v[70:71], v12 offset:31744
    v_cvt_pk_bf16_f32 v94, v100, v101
    v_cvt_pk_bf16_f32 v95, v102, v103
    v_pk_max_i16 v88, v88, 0
    s_waitcnt lgkmcnt(8)
    v_mfma_f32_32x32x16_bf16 v[104:119], v[48:51], a[28:31], v[104:119]
    ds_read_b64_tr_b16 v[48:49], v11 offset:32768
    ds_read_b64_tr_b16 v[50:51], v11 offset:33792
    v_pk_max_i16 v89, v89, 0
    v_pk_max_i16 v90, v90, 0
    v_pk_max_i16 v91, v91, 0
    v_mfma_f32_32x32x16_bf16 v[120:135], v[52:55], a[28:31], v[120:135]
    ds_read_b64_tr_b16 v[52:53], v12 offset:32768
    ds_read_b64_tr_b16 v[54:55], v12 offset:33792
    v_pk_max_i16 v92, v92, 0
    v_pk_max_i16 v93, v93, 0
    v_pk_max_i16 v94, v94, 0
    s_waitcnt lgkmcnt(8)
    v_mfma_f32_32x32x16_bf16 v[104:119], v[56:59], a[32:35], v[104:119]
    ds_read_b64_tr_b16 v[56:57], v11 offset:34816
    ds_read_b64_tr_b16 v[58:59], v11 offset:35840
    v_pk_max_i16 v95, v95, 0
    s_cmp_eq_u32 s41, 0
    s_cbranch_scc1 block_kernel_st45
    buffer_store_dwordx4 v[88:91], v4, s[20:23], 0 offen offset:2048
    buffer_store_dwordx4 v[92:95], v4, s[20:23], 0 offen offset:3072
    s_branch block_kernel_st46
block_kernel_st45:
    buffer_store_dwordx4 v[88:91], v4, s[20:23], 0 offen offset:2048 sc1
    buffer_store_dwordx4 v[92:95], v4, s[20:23], 0 offen offset:3072 sc1
block_kernel_st46:
    v_mfma_f32_32x32x16_bf16 v[120:135], v[60:63], a[32:35], v[120:135]
    ds_read_b64_tr_b16 v[60:61], v12 offset:34816
    ds_read_b64_tr_b16 v[62:63], v12 offset:35840
    s_waitcnt lgkmcnt(8)
    v_mfma_f32_32x32x16_bf16 v[104:119], v[64:67], a[36:39], v[104:119]
    ds_read_b64_tr_b16 v[64:65], v11 offset:36864
    ds_read_b64_tr_b16 v[66:67], v11 offset:37888
    v_mfma_f32_32x32x16_bf16 v[120:135], v[68:71], a[36:39], v[120:135]
    ds_read_b64_tr_b16 v[68:69], v12 offset:36864
    ds_read_b64_tr_b16 v[70:71], v12 offset:37888
    s_waitcnt lgkmcnt(8)
    v_mfma_f32_32x32x16_bf16 v[104:119], v[48:51], a[40:43], v[104:119]
    ds_read_b64_tr_b16 v[48:49], v11 offset:38912
    ds_read_b64_tr_b16 v[50:51], v11 offset:39936
    v_mfma_f32_32x32x16_bf16 v[120:135], v[52:55], a[40:43], v[120:135]
    ds_read_b64_tr_b16 v[52:53], v12 offset:38912
    ds_read_b64_tr_b16 v[54:55], v12 offset:39936
    s_waitcnt lgkmcnt(8)
    v_mfma_f32_32x32x16_bf16 v[104:119], v[56:59], a[44:47], v[104:119]
    ds_read_b64_tr_b16 v[56:57], v11 offset:40960
    ds_read_b64_tr_b16 v[58:59], v11 offset:41984
    v_mfma_f32_32x32x16_bf16 v[120:135], v[60:63], a[44:47], v[120:135]
    ds_read_b64_tr_b16 v[60:61], v12 offset:40960
    ds_read_b64_tr_b16 v[62:63], v12 offset:41984
    s_waitcnt lgkmcnt(8)
    v_mfma_f32_32x32x16_bf16 v[104:119], v[64:67], a[48:51], v[104:119]
    ds_read_b64_tr_b16 v[64:65], v11 offset:43008
    ds_read_b64_tr_b16 v[66:67], v11 offset:44032
    v_mfma_f32_32x32x16_bf16 v[120:135], v[68:71], a[48:51], v[120:135]
    ds_read_b64_tr_b16 v[68:69], v12 offset:43008
    ds_read_b64_tr_b16 v[70:71], v12 offset:44032
    s_lshl_b32 s42, s46, 1
    s_add_u32 s42, s42, s32
    s_mul_i32 s43, s42, 114688
    s_add_u32 s43, s43, 10485760
    s_add_u32 s16, s4, s43
    s_addc_u32 s17, s5, 0
    s_mov_b32 s18, 114688
    s_mov_b32 s19, 0x20000
    s_lshl_b32 s43, s42, 12
    s_add_u32 s43, s43, 17825792
    s_add_u32 s24, s4, s43
    s_addc_u32 s25, s5, 0
    s_mov_b32 s26, 4096
    s_mov_b32 s27, 0x20000
    s_and_b32 s49, s42, 7
    s_lshl_b32 s49, s49, 6
    s_add_u32 s49, s49, 3072
    s_lshl_b32 s34, s33, 11
    s_waitcnt lgkmcnt(8)
    v_mfma_f32_32x32x16_bf16 v[104:119], v[48:51], a[52:55], v[104:119]
    ds_read_b64_tr_b16 v[48:49], v11 offset:45056
    ds_read_b64_tr_b16 v[50:51], v11 offset:46080
    v_mfma_f32_32x32x16_bf16 v[120:135], v[52:55], a[52:55], v[120:135]
    ds_read_b64_tr_b16 v[52:53], v12 offset:45056
    ds_read_b64_tr_b16 v[54:55], v12 offset:46080
    s_waitcnt lgkmcnt(8)
    v_mfma_f32_32x32x16_bf16 v[104:119], v[56:59], a[56:59], v[104:119]
    ds_read_b64_tr_b16 v[56:57], v11 offset:47104
    ds_read_b64_tr_b16 v[58:59], v11 offset:48128
    v_mfma_f32_32x32x16_bf16 v[120:135], v[60:63], a[56:59], v[120:135]
    ds_read_b64_tr_b16 v[60:61], v12 offset:47104
    ds_read_b64_tr_b16 v[62:63], v12 offset:48128
    v_mov_b32 v6, 0
    v_mov_b32 v7, 1
    s_waitcnt vmcnt(0)
    s_mov_b64 exec, 1
    s_cmp_eq_u32 s41, 0
    s_cbranch_scc1 block_kernel_st47
    buffer_store_dword v7, v6, s[28:31], s47 offen
    s_branch block_kernel_st48
block_kernel_st47:
    buffer_store_dword v7, v6, s[28:31], s47 offen sc1
block_kernel_st48:
    s_mov_b64 exec, -1
    s_add_u32 s47, s47, 512
    s_waitcnt lgkmcnt(8)
    v_mfma_f32_32x32x16_bf16 v[104:119], v[64:67], a[60:63], v[104:119]
    ds_read_b64_tr_b16 v[64:65], v11 offset:49152
    ds_read_b64_tr_b16 v[66:67], v11 offset:50176
    v_mfma_f32_32x32x16_bf16 v[120:135], v[68:71], a[60:63], v[120:135]
    ds_read_b64_tr_b16 v[68:69], v12 offset:49152
    ds_read_b64_tr_b16 v[70:71], v12 offset:50176
    s_waitcnt lgkmcnt(8)
    v_mfma_f32_32x32x16_bf16 v[104:119], v[48:51], a[64:67], v[104:119]
    ds_read_b64_tr_b16 v[48:49], v11 offset:51200
    ds_read_b64_tr_b16 v[50:51], v11 offset:52224
    v_mfma_f32_32x32x16_bf16 v[120:135], v[52:55], a[64:67], v[120:135]
    ds_read_b64_tr_b16 v[52:53], v12 offset:51200
    ds_read_b64_tr_b16 v[54:55], v12 offset:52224
    s_waitcnt lgkmcnt(8)
    v_mfma_f32_32x32x16_bf16 v[104:119], v[56:59], a[68:71], v[104:119]
    ds_read_b64_tr_b16 v[56:57], v11 offset:53248
    ds_read_b64_tr_b16 v[58:59], v11 offset:54272
    v_mfma_f32_32x32x16_bf16 v[120:135], v[60:63], a[68:71], v[120:135]
    ds_read_b64_tr_b16 v[60:61], v12 offset:53248
    ds_read_b64_tr_b16 v[62:63], v12 offset:54272
    s_waitcnt lgkmcnt(8)
    v_mfma_f32_32x32x16_bf16 v[104:119], v[64:67], a[72:75], v[104:119]
    ds_read_b64_tr_b16 v[64:65], v11 offset:55296
    ds_read_b64_tr_b16 v[66:67], v11 offset:56320
    v_mfma_f32_32x32x16_bf16 v[120:135], v[68:71], a[72:75], v[120:135]
    ds_read_b64_tr_b16 v[68:69], v12 offset:55296
    ds_read_b64_tr_b16 v[70:71], v12 offset:56320
    s_waitcnt lgkmcnt(8)
    v_mfma_f32_32x32x16_bf16 v[104:119], v[48:51], a[76:79], v[104:119]
    ds_read_b64_tr_b16 v[48:49], v11 offset:57344
    ds_read_b64_tr_b16 v[50:51], v11 offset:58368
    v_mfma_f32_32x32x16_bf16 v[120:135], v[52:55], a[76:79], v[120:135]
    ds_read_b64_tr_b16 v[52:53], v12 offset:57344
    ds_read_b64_tr_b16 v[54:55], v12 offset:58368
    buffer_load_dword v32, v8, s[28:31], s49 offen sc1
    s_waitcnt lgkmcnt(8)
    v_mfma_f32_32x32x16_bf16 v[104:119], v[56:59], a[80:83], v[104:119]
    ds_read_b64_tr_b16 v[56:57], v11 offset:59392
    ds_read_b64_tr_b16 v[58:59], v11 offset:60416
    v_mfma_f32_32x32x16_bf16 v[120:135], v[60:63], a[80:83], v[120:135]
    ds_read_b64_tr_b16 v[60:61], v12 offset:59392
    ds_read_b64_tr_b16 v[62:63], v12 offset:60416
    s_waitcnt lgkmcnt(8)
    v_mfma_f32_32x32x16_bf16 v[104:119], v[64:67], a[84:87], v[104:119]
    ds_read_b64_tr_b16 v[64:65], v11 offset:61440
    ds_read_b64_tr_b16 v[66:67], v11 offset:62464
    v_mfma_f32_32x32x16_bf16 v[120:135], v[68:71], a[84:87], v[120:135]
    ds_read_b64_tr_b16 v[68:69], v12 offset:61440
    ds_read_b64_tr_b16 v[70:71], v12 offset:62464
    s_waitcnt lgkmcnt(8)
    v_mfma_f32_32x32x16_bf16 v[104:119], v[48:51], a[88:91], v[104:119]
    ds_read_b64_tr_b16 v[48:49], v11 offset:63488
    ds_read_b64_tr_b16 v[50:51], v11 offset:64512
    v_mfma_f32_32x32x16_bf16 v[120:135], v[52:55], a[88:91], v[120:135]
    ds_read_b64_tr_b16 v[52:53], v12 offset:63488
    ds_read_b64_tr_b16 v[54:55], v12 offset:64512
    s_waitcnt lgkmcnt(8)
    v_mfma_f32_32x32x16_bf16 v[104:119], v[56:59], a[92:95], v[104:119]
    v_mfma_f32_32x32x16_bf16 v[120:135], v[60:63], a[92:95], v[120:135]
    s_waitcnt lgkmcnt(4)
    v_mfma_f32_32x32x16_bf16 v[104:119], v[64:67], a[96:99], v[104:119]
    v_mfma_f32_32x32x16_bf16 v[120:135], v[68:71], a[96:99], v[120:135]
    ds_read_b128 v[136:139], v9 offset:256
    ds_read_b128 v[140:143], v9 offset:288
    ds_read_b128 v[144:147], v9 offset:320
    ds_read_b128 v[148:151], v9 offset:352
    ds_read_b128 v[16:19], v9 offset:384
    ds_read_b128 v[20:23], v9 offset:416
    ds_read_b128 v[24:27], v9 offset:448
    ds_read_b128 v[28:31], v9 offset:480
    s_waitcnt lgkmcnt(8)
    v_mfma_f32_32x32x16_bf16 v[104:119], v[48:51], a[100:103], v[104:119]
    v_mfma_f32_32x32x16_bf16 v[120:135], v[52:55], a[100:103], v[120:135]
    s_waitcnt lgkmcnt(0)
    v_mov_b32 v6, 154112
    v_mov_b32 v7, 1
    s_mov_b64 exec, 1
    ds_add_u32 v6, v7 offset:8
    s_mov_b64 exec, -1
    s_waitcnt vmcnt(0)
    v_cmp_eq_u32 vcc, 0, v32
    s_and_b32 s42, vcc_lo, 0x3fff
    s_cbranch_scc0 block_kernel_fa49
    v_lshlrev_b32 v6, 2, v1
    s_mov_b32 exec_lo, 16383
    s_mov_b32 exec_hi, 0
    s_mov_b32 s45, 0
block_kernel_pl50:
    buffer_load_dword v7, v6, s[28:31], s49 offen sc1
    s_add_u32 s45, s45, 1
    s_waitcnt vmcnt(0)
    v_cmp_eq_u32 vcc, 0, v7
    s_cmp_ge_u32 s45, 200000
    s_cbranch_vccz block_kernel_pl51
    s_cbranch_scc0 block_kernel_pl50
block_kernel_pl51:
    s_mov_b64 exec, -1
block_kernel_fa49:
    s_add_u32 s43, s34, 0
    buffer_load_dwordx4 a[8:11], v4, s[16:19], s43 offen offset:0 sc1
    buffer_load_dwordx4 a[12:15], v4, s[16:19], s43 offen offset:1024 sc1
    s_add_u32 s43, s34, 8192
    buffer_load_dwordx4 a[16:19], v4, s[16:19], s43 offen offset:0 sc1
    buffer_load_dwordx4 a[20:23], v4, s[16:19], s43 offen offset:1024 sc1
    s_add_u32 s43, s34, 16384
    buffer_load_dwordx4 a[24:27], v4, s[16:19], s43 offen offset:0 sc1
    buffer_load_dwordx4 a[28:31], v4, s[16:19], s43 offen offset:1024 sc1
    s_add_u32 s43, s34, 24576
    buffer_load_dwordx4 a[32:35], v4, s[16:19], s43 offen offset:0 sc1
    buffer_load_dwordx4 a[36:39], v4, s[16:19], s43 offen offset:1024 sc1
    s_mov_b32 s44, 4096
    v_pk_fma_f32 v[104:105], v[136:137], v[14:15], v[104:105] op_sel_hi:[1,0,1]
    v_pk_fma_f32 v[106:107], v[138:139], v[14:15], v[106:107] op_sel_hi:[1,0,1]
    v_pk_fma_f32 v[108:109], v[140:141], v[14:15], v[108:109] op_sel_hi:[1,0,1]
    v_pk_fma_f32 v[110:111], v[142:143], v[14:15], v[110:111] op_sel_hi:[1,0,1]
    v_pk_fma_f32 v[112:113], v[144:145], v[14:15], v[112:113] op_sel_hi:[1,0,1]
    v_pk_fma_f32 v[114:115], v[146:147], v[14:15], v[114:115] op_sel_hi:[1,0,1]
    v_pk_fma_f32 v[116:117], v[148:149], v[14:15], v[116:117] op_sel_hi:[1,0,1]
    v_pk_fma_f32 v[118:119], v[150:151], v[14:15], v[118:119] op_sel_hi:[1,0,1]
    v_cvt_pk_bf16_f32 v104, v104, v105
    v_cvt_pk_bf16_f32 v105, v106, v107
    v_cvt_pk_bf16_f32 v106, v108, v109
    v_cvt_pk_bf16_f32 v107, v110, v111
    v_cvt_pk_bf16_f32 v108, v112, v113
    v_cvt_pk_bf16_f32 v109, v114, v115
    v_cvt_pk_bf16_f32 v110, v116, v117
    v_cvt_pk_bf16_f32 v111, v118, v119
    v_pk_max_i16 v104, v104, 0
    v_pk_max_i16 v105, v105, 0
    v_pk_max_i16 v106, v106, 0
    v_pk_max_i16 v107, v107, 0
    v_pk_max_i16 v108, v108, 0
    v_pk_max_i16 v109, v109, 0
    v_pk_max_i16 v110, v110, 0
    v_pk_max_i16 v111, v111, 0
    s_cmp_eq_u32 s41, 0
    s_cbranch_scc1 block_kernel_st52
    buffer_store_dwordx4 v[104:107], v4, s[20:23], s44 offen offset:0
    buffer_store_dwordx4 v[108:111], v4, s[20:23], s44 offen offset:1024
    s_branch block_kernel_st53
block_kernel_st52:
    buffer_store_dwordx4 v[104:107], v4, s[20:23], s44 offen offset:0 sc1
    buffer_store_dwordx4 v[108:111], v4, s[20:23], s44 offen offset:1024 sc1
block_kernel_st53:
    v_pk_fma_f32 v[120:121], v[16:17], v[14:15], v[120:121] op_sel_hi:[1,0,1]
    v_pk_fma_f32 v[122:123], v[18:19], v[14:15], v[122:123] op_sel_hi:[1,0,1]
    v_pk_fma_f32 v[124:125], v[20:21], v[14:15], v[124:125] op_sel_hi:[1,0,1]
    v_pk_fma_f32 v[126:127], v[22:23], v[14:15], v[126:127] op_sel_hi:[1,0,1]
    v_pk_fma_f32 v[128:129], v[24:25], v[14:15], v[128:129] op_sel_hi:[1,0,1]
    v_pk_fma_f32 v[130:131], v[26:27], v[14:15], v[130:131] op_sel_hi:[1,0,1]
    v_pk_fma_f32 v[132:133], v[28:29], v[14:15], v[132:133] op_sel_hi:[1,0,1]
    v_pk_fma_f32 v[134:135], v[30:31], v[14:15], v[134:135] op_sel_hi:[1,0,1]
    v_cvt_pk_bf16_f32 v120, v120, v121
    v_cvt_pk_bf16_f32 v121, v122, v123
    v_cvt_pk_bf16_f32 v122, v124, v125
    v_cvt_pk_bf16_f32 v123, v126, v127
    v_cvt_pk_bf16_f32 v124, v128, v129
    v_cvt_pk_bf16_f32 v125, v130, v131
    v_cvt_pk_bf16_f32 v126, v132, v133
    v_cvt_pk_bf16_f32 v127, v134, v135
    v_pk_max_i16 v120, v120, 0
    v_pk_max_i16 v121, v121, 0
    v_pk_max_i16 v122, v122, 0
    v_pk_max_i16 v123, v123, 0
    v_pk_max_i16 v124, v124, 0
    v_pk_max_i16 v125, v125, 0
    v_pk_max_i16 v126, v126, 0
    v_pk_max_i16 v127, v127, 0
    s_cmp_eq_u32 s41, 0
    s_cbranch_scc1 block_kernel_st54
    buffer_store_dwordx4 v[120:123], v4, s[20:23], s44 offen offset:2048
    buffer_store_dwordx4 v[124:127], v4, s[20:23], s44 offen offset:3072
    s_branch block_kernel_st55
block_kernel_st54:
    buffer_store_dwordx4 v[120:123], v4, s[20:23], s44 offen offset:2048 sc1
    buffer_store_dwordx4 v[124:127], v4, s[20:23], s44 offen offset:3072 sc1
block_kernel_st55:
    s_branch block_kernel_c5b
block_kernel_c5:
    s_lshl_b32 s42, s46, 1
    s_add_u32 s42, s42, s32
    s_mul_i32 s43, s42, 114688
    s_add_u32 s43, s43, 10485760
    s_add_u32 s16, s4, s43
    s_addc_u32 s17, s5, 0
    s_mov_b32 s18, 114688
    s_mov_b32 s19, 0x20000
    s_lshl_b32 s43, s42, 12
    s_add_u32 s43, s43, 17825792
    s_add_u32 s24, s4, s43
    s_addc_u32 s25, s5, 0
    s_mov_b32 s26, 4096
    s_mov_b32 s27, 0x20000
    s_and_b32 s49, s42, 7
    s_lshl_b32 s49, s49, 6
    s_add_u32 s49, s49, 3072
    s_lshl_b32 s34, s33, 11
    v_lshlrev_b32 v6, 2, v1
    s_mov_b32 exec_lo, 16383
    s_mov_b32 exec_hi, 0
    s_mov_b32 s45, 0
block_kernel_pl56:
    buffer_load_dword v7, v6, s[28:31], s49 offen sc1
    s_add_u32 s45, s45, 1
    s_waitcnt vmcnt(0)
    v_cmp_eq_u32 vcc, 0, v7
    s_cmp_ge_u32 s45, 200000
    s_cbranch_vccz block_kernel_pl57
    s_cbranch_scc0 block_kernel_pl56
block_kernel_pl57:
    s_mov_b64 exec, -1
    v_mov_b32 v6, 154112
    v_mov_b32 v7, 1
    s_waitcnt lgkmcnt(0)
    s_mov_b64 exec, 1
    ds_add_u32 v6, v7 offset:8
    s_mov_b64 exec, -1
    s_add_u32 s43, s34, 0
    buffer_load_dwordx4 a[8:11], v4, s[16:19], s43 offen offset:0 sc1
    buffer_load_dwordx4 a[12:15], v4, s[16:19], s43 offen offset:1024 sc1
    s_add_u32 s43, s34, 8192
    buffer_load_dwordx4 a[16:19], v4, s[16:19], s43 offen offset:0 sc1
    buffer_load_dwordx4 a[20:23], v4, s[16:19], s43 offen offset:1024 sc1
    s_add_u32 s43, s34, 16384
    buffer_load_dwordx4 a[24:27], v4, s[16:19], s43 offen offset:0 sc1
    buffer_load_dwordx4 a[28:31], v4, s[16:19], s43 offen offset:1024 sc1
    s_add_u32 s43, s34, 24576
    buffer_load_dwordx4 a[32:35], v4, s[16:19], s43 offen offset:0 sc1
    buffer_load_dwordx4 a[36:39], v4, s[16:19], s43 offen offset:1024 sc1
    buffer_load_dword v8, v4, s[16:19], 0 offen
    buffer_load_dword v8, v4, s[16:19], 0 offen
    buffer_load_dword v8, v4, s[16:19], 0 offen
    buffer_load_dword v8, v4, s[16:19], 0 offen
block_kernel_c5b:
    s_lshl_b32 s42, s33, 12
    v_add_u32 v11, s42, v10
    v_xor_b32 v12, 64, v11
    v_add_u32 v13, 65536, v11
    v_add_u32 v14, 65536, v12
    v_add_u32 v15, 131072, v11
    v_add_u32 v16, 131072, v12
    v_mov_b32 v6, 154112
block_kernel_wc58:
    ds_read_b32 v7, v6 offset:12
    s_waitcnt lgkmcnt(0)
    v_cmp_gt_u32 vcc, 4, v7
    s_cbranch_vccnz block_kernel_wc58
    ds_read_b64_tr_b16 v[18:19], v15 offset:0
    ds_read_b64_tr_b16 v[20:21], v15 offset:1024
    ds_read_b64_tr_b16 v[22:23], v16 offset:0
    ds_read_b64_tr_b16 v[24:25], v16 offset:1024
    ds_read_b64_tr_b16 v[26:27], v15 offset:2048
    ds_read_b64_tr_b16 v[28:29], v15 offset:3072
    ds_read_b64_tr_b16 v[30:31], v16 offset:2048
    ds_read_b64_tr_b16 v[32:33], v16 offset:3072
    ds_read_b64_tr_b16 v[34:35], v15 offset:8192
    ds_read_b64_tr_b16 v[36:37], v15 offset:9216
    ds_read_b64_tr_b16 v[38:39], v16 offset:8192
    ds_read_b64_tr_b16 v[40:41], v16 offset:9216
    v_lshlrev_b32 v74, 3, v2
    v_lshl_add_u32 v74, v3, 11, v74
    v_lshlrev_b32 v75, 2, v1
    s_add_u32 s49, s49, 512
    s_waitcnt vmcnt(11) lgkmcnt(8)
    v_mfma_f32_32x32x16_bf16 v[42:57], v[18:21], a[8:11], 0
    ds_read_b64_tr_b16 v[18:19], v15 offset:10240
    ds_read_b64_tr_b16 v[20:21], v15 offset:11264
    s_add_u32 s43, s34, 32768
    buffer_load_dwordx4 a[40:43], v4, s[16:19], s43 offen offset:0 sc1
    v_mfma_f32_32x32x16_bf16 v[58:73], v[22:25], a[8:11], 0
    ds_read_b64_tr_b16 v[22:23], v16 offset:10240
    ds_read_b64_tr_b16 v[24:25], v16 offset:11264
    buffer_load_dwordx4 a[44:47], v4, s[16:19], s43 offen offset:1024 sc1
    s_waitcnt vmcnt(12) lgkmcnt(8)
    v_mfma_f32_32x32x16_bf16 v[42:57], v[26:29], a[12:15], v[42:57]
    ds_read_b64_tr_b16 v[26:27], v15 offset:24576
    ds_read_b64_tr_b16 v[28:29], v15 offset:25600
    s_add_u32 s43, s34, 40960
    buffer_load_dwordx4 a[48:51], v4, s[16:19], s43 offen offset:0 sc1
    v_mfma_f32_32x32x16_bf16 v[58:73], v[30:33], a[12:15], v[58:73]
    ds_read_b64_tr_b16 v[30:31], v16 offset:24576
    ds_read_b64_tr_b16 v[32:33], v16 offset:25600
    buffer_load_dwordx4 a[52:55], v4, s[16:19], s43 offen offset:1024 sc1
    s_waitcnt vmcnt(13) lgkmcnt(8)
    v_mfma_f32_32x32x16_bf16 v[42:57], v[34:37], a[16:19], v[42:57]
    ds_read_b64_tr_b16 v[34:35], v15 offset:26624
    ds_read_b64_tr_b16 v[36:37], v15 offset:27648
    s_add_u32 s43, s34, 49152
    buffer_load_dwordx4 a[56:59], v4, s[16:19], s43 offen offset:0 sc1
    v_mfma_f32_32x32x16_bf16 v[58:73], v[38:41], a[16:19], v[58:73]
    ds_read_b64_tr_b16 v[38:39], v16 offset:26624
    ds_read_b64_tr_b16 v[40:41], v16 offset:27648
    buffer_load_dwordx4 a[60:63], v4, s[16:19], s43 offen offset:1024 sc1
    s_cmp_ge_u32 s40, 28
    s_cbranch_scc1 block_kernel_fb59
    v_mov_b32 v6, 0
    v_mov_b32 v7, 1
    s_waitcnt vmcnt(6)
    s_mov_b64 exec, 1
    s_cmp_eq_u32 s41, 0
    s_cbranch_scc1 block_kernel_st60
    buffer_store_dword v7, v6, s[28:31], s47 offen
    s_branch block_kernel_st61
block_kernel_st60:
    buffer_store_dword v7, v6, s[28:31], s47 offen sc1
block_kernel_st61:
    s_mov_b64 exec, -1
block_kernel_fb59:
    s_lshl_b32 s42, s46, 16
    s_add_u32 s20, s10, s42
    s_addc_u32 s21, s11, 0
    s_mov_b32 s22, 65536
    s_mov_b32 s23, 0x20000
    s_waitcnt vmcnt(14) lgkmcnt(8)
    v_mfma_f32_32x32x16_bf16 v[42:57], v[18:21], a[20:23], v[42:57]
    ds_read_b64_tr_b16 v[18:19], v11 offset:0
    ds_read_b64_tr_b16 v[20:21], v11 offset:1024
    s_add_u32 s43, s34, 57344
    buffer_load_dwordx4 a[64:67], v4, s[16:19], s43 offen offset:0 sc1
    v_mfma_f32_32x32x16_bf16 v[58:73], v[22:25], a[20:23], v[58:73]
    ds_read_b64_tr_b16 v[22:23], v12 offset:0
    ds_read_b64_tr_b16 v[24:25], v12 offset:1024
    buffer_load_dwordx4 a[68:71], v4, s[16:19], s43 offen offset:1024 sc1
    s_waitcnt vmcnt(15) lgkmcnt(8)
    v_mfma_f32_32x32x16_bf16 v[42:57], v[26:29], a[24:27], v[42:57]
    ds_read_b64_tr_b16 v[26:27], v11 offset:2048
    ds_read_b64_tr_b16 v[28:29], v11 offset:3072
    s_add_u32 s43, s34, 65536
    buffer_load_dwordx4 a[72:75], v4, s[16:19], s43 offen offset:0 sc1
    v_mfma_f32_32x32x16_bf16 v[58:73], v[30:33], a[24:27], v[58:73]
    ds_read_b64_tr_b16 v[30:31], v12 offset:2048
    ds_read_b64_tr_b16 v[32:33], v12 offset:3072
    buffer_load_dwordx4 a[76:79], v4, s[16:19], s43 offen offset:1024 sc1
    s_waitcnt vmcnt(16) lgkmcnt(8)
    v_mfma_f32_32x32x16_bf16 v[42:57], v[34:37], a[28:31], v[42:57]
    ds_read_b64_tr_b16 v[34:35], v11 offset:8192
    ds_read_b64_tr_b16 v[36:37], v11 offset:9216
    s_add_u32 s43, s34, 73728
    buffer_load_dwordx4 a[80:83], v4, s[16:19], s43 offen offset:0 sc1
    v_mfma_f32_32x32x16_bf16 v[58:73], v[38:41], a[28:31], v[58:73]
    ds_read_b64_tr_b16 v[38:39], v12 offset:8192
    ds_read_b64_tr_b16 v[40:41], v12 offset:9216
    buffer_load_dwordx4 a[84:87], v4, s[16:19], s43 offen offset:1024 sc1
    s_waitcnt vmcnt(17) lgkmcnt(8)
    v_mfma_f32_32x32x16_bf16 v[42:57], v[18:21], a[32:35], v[42:57]
    ds_read_b64_tr_b16 v[18:19], v11 offset:10240
    ds_read_b64_tr_b16 v[20:21], v11 offset:11264
    s_add_u32 s43, s34, 81920
    buffer_load_dwordx4 a[88:91], v4, s[16:19], s43 offen offset:0 sc1
    v_mfma_f32_32x32x16_bf16 v[58:73], v[22:25], a[32:35], v[58:73]
    ds_read_b64_tr_b16 v[22:23], v12 offset:10240
    ds_read_b64_tr_b16 v[24:25], v12 offset:11264
    buffer_load_dwordx4 a[92:95], v4, s[16:19], s43 offen offset:1024 sc1
    s_waitcnt vmcnt(18) lgkmcnt(8)
    v_mfma_f32_32x32x16_bf16 v[42:57], v[26:29], a[36:39], v[42:57]
    ds_read_b64_tr_b16 v[26:27], v11 offset:16384
    ds_read_b64_tr_b16 v[28:29], v11 offset:17408
    s_add_u32 s43, s34, 90112
    buffer_load_dwordx4 a[96:99], v4, s[16:19], s43 offen offset:0 sc1
    v_mfma_f32_32x32x16_bf16 v[58:73], v[30:33], a[36:39], v[58:73]
    ds_read_b64_tr_b16 v[30:31], v12 offset:16384
    ds_read_b64_tr_b16 v[32:33], v12 offset:17408
    buffer_load_dwordx4 a[100:103], v4, s[16:19], s43 offen offset:1024 sc1
    s_waitcnt vmcnt(15) lgkmcnt(8)
    v_mfma_f32_32x32x16_bf16 v[42:57], v[34:37], a[40:43], v[42:57]
    ds_read_b64_tr_b16 v[34:35], v11 offset:18432
    ds_read_b64_tr_b16 v[36:37], v11 offset:19456
    s_add_u32 s43, s34, 98304
    buffer_load_dwordx4 a[8:11], v4, s[16:19], s43 offen offset:0 sc1
    v_mfma_f32_32x32x16_bf16 v[58:73], v[38:41], a[40:43], v[58:73]
    ds_read_b64_tr_b16 v[38:39], v12 offset:18432
    ds_read_b64_tr_b16 v[40:41], v12 offset:19456
    buffer_load_dwordx4 a[12:15], v4, s[16:19], s43 offen offset:1024 sc1
    s_waitcnt vmcnt(16) lgkmcnt(8)
    v_mfma_f32_32x32x16_bf16 v[42:57], v[18:21], a[44:47], v[42:57]
    ds_read_b64_tr_b16 v[18:19], v11 offset:24576
    ds_read_b64_tr_b16 v[20:21], v11 offset:25600
    s_add_u32 s43, s34, 106496
    buffer_load_dwordx4 a[16:19], v4, s[16:19], s43 offen offset:0 sc1
    v_mfma_f32_32x32x16_bf16 v[58:73], v[22:25], a[44:47], v[58:73]
    ds_read_b64_tr_b16 v[22:23], v12 offset:24576
    ds_read_b64_tr_b16 v[24:25], v12 offset:25600
    buffer_load_dwordx4 a[20:23], v4, s[16:19], s43 offen offset:1024 sc1
    s_waitcnt vmcnt(17) lgkmcnt(8)
    v_mfma_f32_32x32x16_bf16 v[42:57], v[26:29], a[48:51], v[42:57]
    ds_read_b64_tr_b16 v[26:27], v11 offset:26624
    ds_read_b64_tr_b16 v[28:29], v11 offset:27648
    v_mfma_f32_32x32x16_bf16 v[58:73], v[30:33], a[48:51], v[58:73]
    ds_read_b64_tr_b16 v[30:31], v12 offset:26624
    ds_read_b64_tr_b16 v[32:33], v12 offset:27648
    s_waitcnt vmcnt(16) lgkmcnt(8)
    v_mfma_f32_32x32x16_bf16 v[42:57], v[34:37], a[52:55], v[42:57]
    ds_read_b64_tr_b16 v[34:35], v11 offset:32768
    ds_read_b64_tr_b16 v[36:37], v11 offset:33792
    v_mfma_f32_32x32x16_bf16 v[58:73], v[38:41], a[52:55], v[58:73]
    ds_read_b64_tr_b16 v[38:39], v12 offset:32768
    ds_read_b64_tr_b16 v[40:41], v12 offset:33792
    s_waitcnt vmcnt(15) lgkmcnt(8)
    v_mfma_f32_32x32x16_bf16 v[42:57], v[18:21], a[56:59], v[42:57]
    ds_read_b64_tr_b16 v[18:19], v11 offset:34816
    ds_read_b64_tr_b16 v[20:21], v11 offset:35840
    v_mfma_f32_32x32x16_bf16 v[58:73], v[22:25], a[56:59], v[58:73]
    ds_read_b64_tr_b16 v[22:23], v12 offset:34816
    ds_read_b64_tr_b16 v[24:25], v12 offset:35840
    buffer_load_dwordx2 v[104:105], v74, s[24:27], 0 offen offset:0 sc1
    buffer_load_dwordx2 v[106:107], v74, s[24:27], 0 offen offset:256 sc1
    buffer_load_dwordx2 v[108:109], v74, s[24:27], 0 offen offset:512 sc1
    buffer_load_dwordx2 v[110:111], v74, s[24:27], 0 offen offset:768 sc1
    buffer_load_dwordx2 v[112:113], v74, s[24:27], 0 offen offset:1024 sc1
    buffer_load_dwordx2 v[114:115], v74, s[24:27], 0 offen offset:1280 sc1
    buffer_load_dwordx2 v[116:117], v74, s[24:27], 0 offen offset:1536 sc1
    buffer_load_dwordx2 v[118:119], v74, s[24:27], 0 offen offset:1792 sc1
    s_waitcnt vmcnt(22) lgkmcnt(8)
    v_mfma_f32_32x32x16_bf16 v[42:57], v[26:29], a[60:63], v[42:57]
    ds_read_b64_tr_b16 v[26:27], v11 offset:40960
    ds_read_b64_tr_b16 v[28:29], v11 offset:41984
    v_mfma_f32_32x32x16_bf16 v[58:73], v[30:33], a[60:63], v[58:73]
    ds_read_b64_tr_b16 v[30:31], v12 offset:40960
    ds_read_b64_tr_b16 v[32:33], v12 offset:41984
    s_waitcnt vmcnt(21) lgkmcnt(8)
    v_mfma_f32_32x32x16_bf16 v[42:57], v[34:37], a[64:67], v[42:57]
    ds_read_b64_tr_b16 v[34:35], v11 offset:43008
    ds_read_b64_tr_b16 v[36:37], v11 offset:44032
    v_mfma_f32_32x32x16_bf16 v[58:73], v[38:41], a[64:67], v[58:73]
    ds_read_b64_tr_b16 v[38:39], v12 offset:43008
    ds_read_b64_tr_b16 v[40:41], v12 offset:44032
    s_waitcnt vmcnt(20) lgkmcnt(8)
    v_mfma_f32_32x32x16_bf16 v[42:57], v[18:21], a[68:71], v[42:57]
    ds_read_b64_tr_b16 v[18:19], v11 offset:49152
    ds_read_b64_tr_b16 v[20:21], v11 offset:50176
    v_mfma_f32_32x32x16_bf16 v[58:73], v[22:25], a[68:71], v[58:73]
    ds_read_b64_tr_b16 v[22:23], v12 offset:49152
    ds_read_b64_tr_b16 v[24:25], v12 offset:50176
    s_waitcnt vmcnt(19) lgkmcnt(8)
    v_mfma_f32_32x32x16_bf16 v[42:57], v[26:29], a[72:75], v[42:57]
    ds_read_b64_tr_b16 v[26:27], v11 offset:51200
    ds_read_b64_tr_b16 v[28:29], v11 offset:52224
    v_mfma_f32_32x32x16_bf16 v[58:73], v[30:33], a[72:75], v[58:73]
    ds_read_b64_tr_b16 v[30:31], v12 offset:51200
    ds_read_b64_tr_b16 v[32:33], v12 offset:52224
    s_waitcnt vmcnt(18) lgkmcnt(8)
    v_mfma_f32_32x32x16_bf16 v[42:57], v[34:37], a[76:79], v[42:57]
    ds_read_b64_tr_b16 v[34:35], v11 offset:57344
    ds_read_b64_tr_b16 v[36:37], v11 offset:58368
    v_mfma_f32_32x32x16_bf16 v[58:73], v[38:41], a[76:79], v[58:73]
    ds_read_b64_tr_b16 v[38:39], v12 offset:57344
    ds_read_b64_tr_b16 v[40:41], v12 offset:58368
    buffer_load_dword v136, v75, s[28:31], s49 offen sc1
    s_waitcnt vmcnt(18) lgkmcnt(8)
    v_mfma_f32_32x32x16_bf16 v[42:57], v[18:21], a[80:83], v[42:57]
    ds_read_b64_tr_b16 v[18:19], v11 offset:59392
    ds_read_b64_tr_b16 v[20:21], v11 offset:60416
    v_mfma_f32_32x32x16_bf16 v[58:73], v[22:25], a[80:83], v[58:73]
    ds_read_b64_tr_b16 v[22:23], v12 offset:59392
    ds_read_b64_tr_b16 v[24:25], v12 offset:60416
    s_waitcnt vmcnt(17) lgkmcnt(8)
    v_mfma_f32_32x32x16_bf16 v[42:57], v[26:29], a[84:87], v[42:57]
    s_waitcnt lgkmcnt(0)
    s_barrier
    ds_read_b64_tr_b16 v[26:27], v13 offset:0
    ds_read_b64_tr_b16 v[28:29], v13 offset:1024
    v_mfma_f32_32x32x16_bf16 v[58:73], v[30:33], a[84:87], v[58:73]
    ds_read_b64_tr_b16 v[30:31], v14 offset:0
    ds_read_b64_tr_b16 v[32:33], v14 offset:1024
    s_waitcnt vmcnt(16)
    v_mfma_f32_32x32x16_bf16 v[42:57], v[34:37], a[88:91], v[42:57]
    ds_read_b64_tr_b16 v[34:35], v13 offset:2048
    ds_read_b64_tr_b16 v[36:37], v13 offset:3072
    v_mfma_f32_32x32x16_bf16 v[58:73], v[38:41], a[88:91], v[58:73]
    ds_read_b64_tr_b16 v[38:39], v14 offset:2048
    ds_read_b64_tr_b16 v[40:41], v14 offset:3072
    s_waitcnt vmcnt(15)
    v_mfma_f32_32x32x16_bf16 v[42:57], v[18:21], a[92:95], v[42:57]
    ds_read_b64_tr_b16 v[18:19], v13 offset:8192
    ds_read_b64_tr_b16 v[20:21], v13 offset:9216
    v_mfma_f32_32x32x16_bf16 v[58:73], v[22:25], a[92:95], v[58:73]
    ds_read_b64_tr_b16 v[22:23], v14 offset:8192
    ds_read_b64_tr_b16 v[24:25], v14 offset:9216
    s_waitcnt vmcnt(14) lgkmcnt(8)
    v_mfma_f32_32x32x16_bf16 v[42:57], v[26:29], a[96:99], v[42:57]
    ds_read_b64_tr_b16 v[26:27], v13 offset:10240
    ds_read_b64_tr_b16 v[28:29], v13 offset:11264
    v_mfma_f32_32x32x16_bf16 v[58:73], v[30:33], a[96:99], v[58:73]
    ds_read_b64_tr_b16 v[30:31], v14 offset:10240
    ds_read_b64_tr_b16 v[32:33], v14 offset:11264
    s_waitcnt vmcnt(0)
    v_cmp_eq_u32 vcc, 0, v136
    s_and_b32 s42, vcc_lo, 0x3fff
    s_cbranch_scc0 block_kernel_fb62
    v_lshlrev_b32 v6, 2, v1
    s_mov_b32 exec_lo, 16383
    s_mov_b32 exec_hi, 0
    s_mov_b32 s45, 0
block_kernel_pl63:
    buffer_load_dword v7, v6, s[28:31], s49 offen sc1
    s_add_u32 s45, s45, 1
    s_waitcnt vmcnt(0)
    v_cmp_eq_u32 vcc, 0, v7
    s_cmp_ge_u32 s45, 200000
    s_cbranch_vccz block_kernel_pl64
    s_cbranch_scc0 block_kernel_pl63
block_kernel_pl64:
    s_mov_b64 exec, -1
block_kernel_fb62:
    s_waitcnt lgkmcnt(8)
    v_mfma_f32_32x32x16_bf16 v[42:57], v[34:37], a[100:103], v[42:57]
    ds_read_b64_tr_b16 v[34:35], v13 offset:16384
    ds_read_b64_tr_b16 v[36:37], v13 offset:17408
    s_add_u32 s43, s34, 4096
    buffer_load_dwordx4 a[24:27], v4, s[16:19], s43 offen offset:0 sc1
    v_mfma_f32_32x32x16_bf16 v[58:73], v[38:41], a[100:103], v[58:73]
    ds_read_b64_tr_b16 v[38:39], v14 offset:16384
    ds_read_b64_tr_b16 v[40:41], v14 offset:17408
    buffer_load_dwordx4 a[28:31], v4, s[16:19], s43 offen offset:1024 sc1
    s_waitcnt lgkmcnt(8)
    v_mfma_f32_32x32x16_bf16 v[42:57], v[18:21], a[8:11], v[42:57]
    ds_read_b64_tr_b16 v[18:19], v13 offset:18432
    ds_read_b64_tr_b16 v[20:21], v13 offset:19456
    s_add_u32 s43, s34, 12288
    buffer_load_dwordx4 a[32:35], v4, s[16:19], s43 offen offset:0 sc1
    v_mfma_f32_32x32x16_bf16 v[58:73], v[22:25], a[8:11], v[58:73]
    ds_read_b64_tr_b16 v[22:23], v14 offset:18432
    ds_read_b64_tr_b16 v[24:25], v14 offset:19456
    buffer_load_dwordx4 a[36:39], v4, s[16:19], s43 offen offset:1024 sc1
    s_waitcnt lgkmcnt(8)
    v_mfma_f32_32x32x16_bf16 v[42:57], v[26:29], a[12:15], v[42:57]
    ds_read_b64_tr_b16 v[26:27], v13 offset:24576
    ds_read_b64_tr_b16 v[28:29], v13 offset:25600
    s_add_u32 s43, s34, 20480
    buffer_load_dwordx4 a[40:43], v4, s[16:19], s43 offen offset:0 sc1
    v_mfma_f32_32x32x16_bf16 v[58:73], v[30:33], a[12:15], v[58:73]
    ds_read_b64_tr_b16 v[30:31], v14 offset:24576
    ds_read_b64_tr_b16 v[32:33], v14 offset:25600
    buffer_load_dwordx4 a[44:47], v4, s[16:19], s43 offen offset:1024 sc1
    s_waitcnt lgkmcnt(8)
    v_mfma_f32_32x32x16_bf16 v[42:57], v[34:37], a[16:19], v[42:57]
    ds_read_b64_tr_b16 v[34:35], v13 offset:26624
    ds_read_b64_tr_b16 v[36:37], v13 offset:27648
    s_add_u32 s43, s34, 28672
    buffer_load_dwordx4 a[48:51], v4, s[16:19], s43 offen offset:0 sc1
    v_mfma_f32_32x32x16_bf16 v[58:73], v[38:41], a[16:19], v[58:73]
    ds_read_b64_tr_b16 v[38:39], v14 offset:26624
    ds_read_b64_tr_b16 v[40:41], v14 offset:27648
    buffer_load_dwordx4 a[52:55], v4, s[16:19], s43 offen offset:1024 sc1
    s_waitcnt lgkmcnt(8)
    v_mfma_f32_32x32x16_bf16 v[42:57], v[18:21], a[20:23], v[42:57]
    ds_read_b64_tr_b16 v[18:19], v13 offset:32768
    ds_read_b64_tr_b16 v[20:21], v13 offset:33792
    s_add_u32 s43, s34, 36864
    buffer_load_dwordx4 a[56:59], v4, s[16:19], s43 offen offset:0 sc1
    v_mfma_f32_32x32x16_bf16 v[58:73], v[22:25], a[20:23], v[58:73]
    ds_read_b64_tr_b16 v[22:23], v14 offset:32768
    ds_read_b64_tr_b16 v[24:25], v14 offset:33792
    buffer_load_dwordx4 a[60:63], v4, s[16:19], s43 offen offset:1024 sc1
    s_waitcnt vmcnt(9) lgkmcnt(8)
    v_mfma_f32_32x32x16_bf16 v[42:57], v[26:29], a[24:27], v[42:57]
    ds_read_b64_tr_b16 v[26:27], v13 offset:34816
    ds_read_b64_tr_b16 v[28:29], v13 offset:35840
    s_add_u32 s43, s34, 45056
    buffer_load_dwordx4 a[64:67], v4, s[16:19], s43 offen offset:0 sc1
    v_mfma_f32_32x32x16_bf16 v[58:73], v[30:33], a[24:27], v[58:73]
    ds_read_b64_tr_b16 v[30:31], v14 offset:34816
    ds_read_b64_tr_b16 v[32:33], v14 offset:35840
    buffer_load_dwordx4 a[68:71], v4, s[16:19], s43 offen offset:1024 sc1
    s_waitcnt vmcnt(10) lgkmcnt(8)
    v_mfma_f32_32x32x16_bf16 v[42:57], v[34:37], a[28:31], v[42:57]
    ds_read_b64_tr_b16 v[34:35], v13 offset:40960
    ds_read_b64_tr_b16 v[36:37], v13 offset:41984
    s_add_u32 s43, s34, 53248
    buffer_load_dwordx4 a[72:75], v4, s[16:19], s43 offen offset:0 sc1
    v_mfma_f32_32x32x16_bf16 v[58:73], v[38:41], a[28:31], v[58:73]
    ds_read_b64_tr_b16 v[38:39], v14 offset:40960
    ds_read_b64_tr_b16 v[40:41], v14 offset:41984
    buffer_load_dwordx4 a[76:79], v4, s[16:19], s43 offen offset:1024 sc1
    s_waitcnt vmcnt(11) lgkmcnt(8)
    v_mfma_f32_32x32x16_bf16 v[42:57], v[18:21], a[32:35], v[42:57]
    ds_read_b64_tr_b16 v[18:19], v13 offset:43008
    ds_read_b64_tr_b16 v[20:21], v13 offset:44032
    s_add_u32 s43, s34, 61440
    buffer_load_dwordx4 a[80:83], v4, s[16:19], s43 offen offset:0 sc1
    v_mfma_f32_32x32x16_bf16 v[58:73], v[22:25], a[32:35], v[58:73]
    ds_read_b64_tr_b16 v[22:23], v14 offset:43008
    ds_read_b64_tr_b16 v[24:25], v14 offset:44032
    buffer_load_dwordx4 a[84:87], v4, s[16:19], s43 offen offset:1024 sc1
    s_waitcnt vmcnt(12) lgkmcnt(8)
    v_mfma_f32_32x32x16_bf16 v[42:57], v[26:29], a[36:39], v[42:57]
    ds_read_b64_tr_b16 v[26:27], v13 offset:49152
    ds_read_b64_tr_b16 v[28:29], v13 offset:50176
    s_add_u32 s43, s34, 69632
    buffer_load_dwordx4 a[88:91], v4, s[16:19], s43 offen offset:0 sc1
    v_mfma_f32_32x32x16_bf16 v[58:73], v[30:33], a[36:39], v[58:73]
    ds_read_b64_tr_b16 v[30:31], v14 offset:49152
    ds_read_b64_tr_b16 v[32:33], v14 offset:50176
    buffer_load_dwordx4 a[92:95], v4, s[16:19], s43 offen offset:1024 sc1
    s_waitcnt vmcnt(13) lgkmcnt(8)
    v_mfma_f32_32x32x16_bf16 v[42:57], v[34:37], a[40:43], v[42:57]
    ds_read_b64_tr_b16 v[34:35], v13 offset:51200
    ds_read_b64_tr_b16 v[36:37], v13 offset:52224
    s_add_u32 s43, s34, 77824
    buffer_load_dwordx4 a[96:99], v4, s[16:19], s43 offen offset:0 sc1
    v_mfma_f32_32x32x16_bf16 v[58:73], v[38:41], a[40:43], v[58:73]
    ds_read_b64_tr_b16 v[38:39], v14 offset:51200
    ds_read_b64_tr_b16 v[40:41], v14 offset:52224
    buffer_load_dwordx4 a[100:103], v4, s[16:19], s43 offen offset:1024 sc1
    s_waitcnt vmcnt(14) lgkmcnt(8)
    v_mfma_f32_32x32x16_bf16 v[42:57], v[18:21], a[44:47], v[42:57]
    ds_read_b64_tr_b16 v[18:19], v13 offset:57344
    ds_read_b64_tr_b16 v[20:21], v13 offset:58368
    s_add_u32 s43, s34, 86016
    buffer_load_dwordx4 a[8:11], v4, s[16:19], s43 offen offset:0 sc1
    v_mfma_f32_32x32x16_bf16 v[58:73], v[22:25], a[44:47], v[58:73]
    ds_read_b64_tr_b16 v[22:23], v14 offset:57344
    ds_read_b64_tr_b16 v[24:25], v14 offset:58368
    buffer_load_dwordx4 a[12:15], v4, s[16:19], s43 offen offset:1024 sc1
    s_waitcnt vmcnt(15) lgkmcnt(8)
    v_mfma_f32_32x32x16_bf16 v[42:57], v[26:29], a[48:51], v[42:57]
    ds_read_b64_tr_b16 v[26:27], v13 offset:59392
    ds_read_b64_tr_b16 v[28:29], v13 offset:60416
    s_add_u32 s43, s34, 94208
    buffer_load_dwordx4 a[16:19], v4, s[16:19], s43 offen offset:0 sc1
    v_mfma_f32_32x32x16_bf16 v[58:73], v[30:33], a[48:51], v[58:73]
    ds_read_b64_tr_b16 v[30:31], v14 offset:59392
    ds_read_b64_tr_b16 v[32:33], v14 offset:60416
    buffer_load_dwordx4 a[20:23], v4, s[16:19], s43 offen offset:1024 sc1
    s_waitcnt vmcnt(16) lgkmcnt(8)
    v_mfma_f32_32x32x16_bf16 v[42:57], v[34:37], a[52:55], v[42:57]
    s_waitcnt lgkmcnt(0)
    s_barrier
    ds_read_b64_tr_b16 v[34:35], v15 offset:16384
    ds_read_b64_tr_b16 v[36:37], v15 offset:17408
    s_add_u32 s43, s34, 102400
    buffer_load_dwordx4 a[24:27], v4, s[16:19], s43 offen offset:0 sc1
    v_mfma_f32_32x32x16_bf16 v[58:73], v[38:41], a[52:55], v[58:73]
    ds_read_b64_tr_b16 v[38:39], v16 offset:16384
    ds_read_b64_tr_b16 v[40:41], v16 offset:17408
    buffer_load_dwordx4 a[28:31], v4, s[16:19], s43 offen offset:1024 sc1
    s_waitcnt vmcnt(17)
    v_mfma_f32_32x32x16_bf16 v[42:57], v[18:21], a[56:59], v[42:57]
    ds_read_b64_tr_b16 v[18:19], v15 offset:18432
    ds_read_b64_tr_b16 v[20:21], v15 offset:19456
    s_add_u32 s43, s34, 110592
    buffer_load_dwordx4 a[32:35], v4, s[16:19], s43 offen offset:0 sc1
    v_mfma_f32_32x32x16_bf16 v[58:73], v[22:25], a[56:59], v[58:73]
    ds_read_b64_tr_b16 v[22:23], v16 offset:18432
    ds_read_b64_tr_b16 v[24:25], v16 offset:19456
    buffer_load_dwordx4 a[36:39], v4, s[16:19], s43 offen offset:1024 sc1
    s_waitcnt vmcnt(18)
    v_mfma_f32_32x32x16_bf16 v[42:57], v[26:29], a[60:63], v[42:57]
    ds_read_b64_tr_b16 v[26:27], v15 offset:0
    ds_read_b64_tr_b16 v[28:29], v15 offset:1024
    v_mfma_f32_32x32x16_bf16 v[58:73], v[30:33], a[60:63], v[58:73]
    ds_read_b64_tr_b16 v[30:31], v16 offset:0
    ds_read_b64_tr_b16 v[32:33], v16 offset:1024
    s_waitcnt vmcnt(17) lgkmcnt(8)
    v_mfma_f32_32x32x16_bf16 v[42:57], v[34:37], a[64:67], v[42:57]
    ds_read_b64_tr_b16 v[34:35], v15 offset:2048
    ds_read_b64_tr_b16 v[36:37], v15 offset:3072
    v_mfma_f32_32x32x16_bf16 v[58:73], v[38:41], a[64:67], v[58:73]
    ds_read_b64_tr_b16 v[38:39], v16 offset:2048
    ds_read_b64_tr_b16 v[40:41], v16 offset:3072
    s_waitcnt vmcnt(16) lgkmcnt(8)
    v_mfma_f32_32x32x16_bf16 v[42:57], v[18:21], a[68:71], v[42:57]
    ds_read_b64_tr_b16 v[18:19], v15 offset:8192
    ds_read_b64_tr_b16 v[20:21], v15 offset:9216
    v_mfma_f32_32x32x16_bf16 v[58:73], v[22:25], a[68:71], v[58:73]
    ds_read_b64_tr_b16 v[22:23], v16 offset:8192
    ds_read_b64_tr_b16 v[24:25], v16 offset:9216
    s_waitcnt vmcnt(15) lgkmcnt(8)
    v_mfma_f32_32x32x16_bf16 v[42:57], v[26:29], a[72:75], v[42:57]
    s_barrier
    ds_read_b64_tr_b16 v[26:27], v15 offset:10240
    ds_read_b64_tr_b16 v[28:29], v15 offset:11264
    v_mfma_f32_32x32x16_bf16 v[58:73], v[30:33], a[72:75], v[58:73]
    ds_read_b64_tr_b16 v[30:31], v16 offset:10240
    ds_read_b64_tr_b16 v[32:33], v16 offset:11264
    s_waitcnt vmcnt(14) lgkmcnt(8)
    v_mfma_f32_32x32x16_bf16 v[42:57], v[34:37], a[76:79], v[42:57]
    ds_read_b64_tr_b16 v[34:35], v15 offset:24576
    ds_read_b64_tr_b16 v[36:37], v15 offset:25600
    v_mfma_f32_32x32x16_bf16 v[58:73], v[38:41], a[76:79], v[58:73]
    ds_read_b64_tr_b16 v[38:39], v16 offset:24576
    ds_read_b64_tr_b16 v[40:41], v16 offset:25600
    s_waitcnt vmcnt(13) lgkmcnt(8)
    v_mfma_f32_32x32x16_bf16 v[42:57], v[18:21], a[80:83], v[42:57]
    ds_read_b64_tr_b16 v[18:19], v15 offset:26624
    ds_read_b64_tr_b16 v[20:21], v15 offset:27648
    v_mfma_f32_32x32x16_bf16 v[58:73], v[22:25], a[80:83], v[58:73]
    ds_read_b64_tr_b16 v[22:23], v16 offset:26624
    ds_read_b64_tr_b16 v[24:25], v16 offset:27648
    s_waitcnt vmcnt(12) lgkmcnt(8)
    v_mfma_f32_32x32x16_bf16 v[42:57], v[26:29], a[84:87], v[42:57]
    ds_read_b64_tr_b16 v[26:27], v11 offset:0
    ds_read_b64_tr_b16 v[28:29], v11 offset:1024
    v_mfma_f32_32x32x16_bf16 v[58:73], v[30:33], a[84:87], v[58:73]
    ds_read_b64_tr_b16 v[30:31], v12 offset:0
    ds_read_b64_tr_b16 v[32:33], v12 offset:1024
    s_waitcnt vmcnt(11) lgkmcnt(8)
    v_mfma_f32_32x32x16_bf16 v[42:57], v[34:37], a[88:91], v[42:57]
    ds_read_b64_tr_b16 v[34:35], v11 offset:2048
    ds_read_b64_tr_b16 v[36:37], v11 offset:3072
    v_mfma_f32_32x32x16_bf16 v[58:73], v[38:41], a[88:91], v[58:73]
    ds_read_b64_tr_b16 v[38:39], v12 offset:2048
    ds_read_b64_tr_b16 v[40:41], v12 offset:3072
    s_waitcnt vmcnt(10) lgkmcnt(8)
    v_mfma_f32_32x32x16_bf16 v[42:57], v[18:21], a[92:95], v[42:57]
    ds_read_b64_tr_b16 v[18:19], v11 offset:8192
    ds_read_b64_tr_b16 v[20:21], v11 offset:9216
    v_mfma_f32_32x32x16_bf16 v[58:73], v[22:25], a[92:95], v[58:73]
    ds_read_b64_tr_b16 v[22:23], v12 offset:8192
    ds_read_b64_tr_b16 v[24:25], v12 offset:9216
    s_waitcnt vmcnt(9) lgkmcnt(8)
    v_mfma_f32_32x32x16_bf16 v[42:57], v[26:29], a[96:99], v[42:57]
    ds_read_b64_tr_b16 v[26:27], v11 offset:10240
    ds_read_b64_tr_b16 v[28:29], v11 offset:11264
    v_mfma_f32_32x32x16_bf16 v[58:73], v[30:33], a[96:99], v[58:73]
    ds_read_b64_tr_b16 v[30:31], v12 offset:10240
    ds_read_b64_tr_b16 v[32:33], v12 offset:11264
    v_accvgpr_read_b32 v120, a0
    v_accvgpr_read_b32 v121, a1
    v_accvgpr_read_b32 v122, a2
    v_accvgpr_read_b32 v123, a3
    v_accvgpr_read_b32 v124, a4
    v_accvgpr_read_b32 v125, a5
    v_accvgpr_read_b32 v126, a6
    v_accvgpr_read_b32 v127, a7
    s_waitcnt vmcnt(8) lgkmcnt(8)
    v_mfma_f32_32x32x16_bf16 v[42:57], v[34:37], a[100:103], v[42:57]
    ds_read_b64_tr_b16 v[34:35], v11 offset:16384
    ds_read_b64_tr_b16 v[36:37], v11 offset:17408
    v_mfma_f32_32x32x16_bf16 v[58:73], v[38:41], a[100:103], v[58:73]
    ds_read_b64_tr_b16 v[38:39], v12 offset:16384
    ds_read_b64_tr_b16 v[40:41], v12 offset:17408
    s_waitcnt vmcnt(7) lgkmcnt(8)
    v_mfma_f32_32x32x16_bf16 v[42:57], v[18:21], a[8:11], v[42:57]
    ds_read_b64_tr_b16 v[18:19], v11 offset:18432
    ds_read_b64_tr_b16 v[20:21], v11 offset:19456
    v_mfma_f32_32x32x16_bf16 v[58:73], v[22:25], a[8:11], v[58:73]
    ds_read_b64_tr_b16 v[22:23], v12 offset:18432
    ds_read_b64_tr_b16 v[24:25], v12 offset:19456
    s_waitcnt vmcnt(6) lgkmcnt(8)
    v_mfma_f32_32x32x16_bf16 v[42:57], v[26:29], a[12:15], v[42:57]
    ds_read_b64_tr_b16 v[26:27], v11 offset:24576
    ds_read_b64_tr_b16 v[28:29], v11 offset:25600
    v_mfma_f32_32x32x16_bf16 v[58:73], v[30:33], a[12:15], v[58:73]
    ds_read_b64_tr_b16 v[30:31], v12 offset:24576
    ds_read_b64_tr_b16 v[32:33], v12 offset:25600
    v_add_f32 v104, v104, v112
    v_add_f32 v105, v105, v113
    v_add_f32 v106, v106, v114
    v_add_f32 v107, v107, v115
    v_add_f32 v108, v108, v116
    v_add_f32 v109, v109, v117
    v_add_f32 v110, v110, v118
    v_add_f32 v111, v111, v119
    s_waitcnt vmcnt(5) lgkmcnt(8)
    v_mfma_f32_32x32x16_bf16 v[42:57], v[34:37], a[16:19], v[42:57]
    ds_read_b64_tr_b16 v[34:35], v11 offset:26624
    ds_read_b64_tr_b16 v[36:37], v11 offset:27648
    v_mfma_f32_32x32x16_bf16 v[58:73], v[38:41], a[16:19], v[58:73]
    ds_read_b64_tr_b16 v[38:39], v12 offset:26624
    ds_read_b64_tr_b16 v[40:41], v12 offset:27648
    v_add_f32 v104, v104, v108
    v_add_f32 v105, v105, v109
    v_add_f32 v106, v106, v110
    v_add_f32 v107, v107, v111
    v_add_f32 v104, v104, v106
    v_add_f32 v105, v105, v107
    s_waitcnt vmcnt(4) lgkmcnt(8)
    v_mfma_f32_32x32x16_bf16 v[42:57], v[18:21], a[20:23], v[42:57]
    ds_read_b64_tr_b16 v[18:19], v11 offset:32768
    ds_read_b64_tr_b16 v[20:21], v11 offset:33792
    v_mfma_f32_32x32x16_bf16 v[58:73], v[22:25], a[20:23], v[58:73]
    ds_read_b64_tr_b16 v[22:23], v12 offset:32768
    ds_read_b64_tr_b16 v[24:25], v12 offset:33792
    v_mov_b32 v106, v104
    v_mov_b32 v107, v105
    s_nop 1
    v_permlane32_swap_b32 v104, v106
    v_permlane32_swap_b32 v105, v107
    s_nop 1
    v_add_f32 v104, v104, v106
    v_add_f32 v105, v105, v107
    s_waitcnt vmcnt(3) lgkmcnt(8)
    v_mfma_f32_32x32x16_bf16 v[42:57], v[26:29], a[24:27], v[42:57]
    ds_read_b64_tr_b16 v[26:27], v11 offset:34816
    ds_read_b64_tr_b16 v[28:29], v11 offset:35840
    v_mfma_f32_32x32x16_bf16 v[58:73], v[30:33], a[24:27], v[58:73]
    ds_read_b64_tr_b16 v[30:31], v12 offset:34816
    ds_read_b64_tr_b16 v[32:33], v12 offset:35840
    s_waitcnt vmcnt(2) lgkmcnt(8)
    v_mfma_f32_32x32x16_bf16 v[42:57], v[34:37], a[28:31], v[42:57]
    v_mfma_f32_32x32x16_bf16 v[58:73], v[38:41], a[28:31], v[58:73]
    v_mul_f32 v136, 0x3b000000, v104
    v_mul_f32 v105, 0x3b000000, v105
    v_fma_f32 v138, -v136, v136, v105
    v_max_f32 v138, 0, v138
    v_cvt_pk_bf16_f32 v136, v136, v136
    v_and_b32 v136, 0xffff0000, v136
    v_cvt_pk_bf16_f32 v138, v138, v138
    v_and_b32 v138, 0xffff0000, v138
    v_add_f32 v138, 0x3727c5ac, v138
    v_cvt_pk_bf16_f32 v138, v138, v138
    v_and_b32 v138, 0xffff0000, v138
    v_sqrt_f32 v138, v138
    s_nop 0
    v_cvt_pk_bf16_f32 v138, v138, v138
    v_and_b32 v138, 0xffff0000, v138
    v_rcp_f32 v138, v138
    s_nop 0
    s_waitcnt vmcnt(1) lgkmcnt(4)
    v_mfma_f32_32x32x16_bf16 v[42:57], v[18:21], a[32:35], v[42:57]
    v_mfma_f32_32x32x16_bf16 v[58:73], v[22:25], a[32:35], v[58:73]
    s_waitcnt vmcnt(0) lgkmcnt(0)
    v_mfma_f32_32x32x16_bf16 v[42:57], v[26:29], a[36:39], v[42:57]
    v_mfma_f32_32x32x16_bf16 v[58:73], v[30:33], a[36:39], v[58:73]
    s_xor_b32 s42, s37, 1
    s_lshl_b32 s42, s42, 12
    s_add_u32 s42, s42, 65536
    v_add_u32 v13, s42, v4
    v_xor_b32 v11, 4096, v13
    v_lshlrev_b32 v74, 10, v2
    v_lshl_add_u32 v74, v3, 4, v74
    s_lshl_b32 s42, s32, 15
    s_lshl_b32 s43, s48, 7
    s_add_u32 s42, s42, s43
    s_lshl_b32 s43, s33, 6
    s_add_u32 s42, s42, s43
    ds_write_b128 v13, v[58:61] offset:0
    ds_write_b128 v13, v[62:65] offset:1024
    ds_write_b128 v13, v[66:69] offset:2048
    ds_write_b128 v13, v[70:73] offset:3072
    v_lshlrev_b32 v18, 16, v120
    v_and_b32 v19, 0xffff0000, v120
    v_lshlrev_b32 v20, 16, v121
    v_and_b32 v21, 0xffff0000, v121
    v_lshlrev_b32 v22, 16, v122
    v_and_b32 v23, 0xffff0000, v122
    v_lshlrev_b32 v24, 16, v123
    v_and_b32 v25, 0xffff0000, v123
    v_lshlrev_b32 v26, 16, v124
    v_and_b32 v27, 0xffff0000, v124
    v_lshlrev_b32 v28, 16, v125
    v_and_b32 v29, 0xffff0000, v125
    v_lshlrev_b32 v30, 16, v126
    v_and_b32 v31, 0xffff0000, v126
    v_lshlrev_b32 v32, 16, v127
    v_and_b32 v33, 0xffff0000, v127
    v_pk_fma_f32 v[18:19], v[42:43], v[138:139], v[18:19] op_sel_hi:[1,0,1]
    v_pk_fma_f32 v[20:21], v[44:45], v[138:139], v[20:21] op_sel_hi:[1,0,1]
    v_pk_fma_f32 v[22:23], v[46:47], v[138:139], v[22:23] op_sel_hi:[1,0,1]
    v_pk_fma_f32 v[24:25], v[48:49], v[138:139], v[24:25] op_sel_hi:[1,0,1]
    v_pk_fma_f32 v[26:27], v[50:51], v[138:139], v[26:27] op_sel_hi:[1,0,1]
    v_pk_fma_f32 v[28:29], v[52:53], v[138:139], v[28:29] op_sel_hi:[1,0,1]
    v_pk_fma_f32 v[30:31], v[54:55], v[138:139], v[30:31] op_sel_hi:[1,0,1]
    v_pk_fma_f32 v[32:33], v[56:57], v[138:139], v[32:33] op_sel_hi:[1,0,1]
    s_waitcnt lgkmcnt(0)
    s_barrier
    ds_read_b128 v[58:61], v11 offset:0
    ds_read_b128 v[62:65], v11 offset:1024
    ds_read_b128 v[66:69], v11 offset:2048
    ds_read_b128 v[70:73], v11 offset:3072
    s_waitcnt lgkmcnt(3)
    v_pk_fma_f32 v[18:19], v[58:59], v[138:139], v[18:19] op_sel_hi:[1,0,1]
    v_pk_fma_f32 v[20:21], v[60:61], v[138:139], v[20:21] op_sel_hi:[1,0,1]
    s_waitcnt lgkmcnt(2)
    v_pk_fma_f32 v[22:23], v[62:63], v[138:139], v[22:23] op_sel_hi:[1,0,1]
    v_pk_fma_f32 v[24:25], v[64:65], v[138:139], v[24:25] op_sel_hi:[1,0,1]
    s_waitcnt lgkmcnt(1)
    v_pk_fma_f32 v[26:27], v[66:67], v[138:139], v[26:27] op_sel_hi:[1,0,1]
    v_pk_fma_f32 v[28:29], v[68:69], v[138:139], v[28:29] op_sel_hi:[1,0,1]
    s_waitcnt lgkmcnt(0)
    v_pk_fma_f32 v[30:31], v[70:71], v[138:139], v[30:31] op_sel_hi:[1,0,1]
    v_pk_fma_f32 v[32:33], v[72:73], v[138:139], v[32:33] op_sel_hi:[1,0,1]
    v_cvt_pk_bf16_f32 v104, v18, v19
    v_cvt_pk_bf16_f32 v105, v20, v21
    v_cvt_pk_bf16_f32 v106, v22, v23
    v_cvt_pk_bf16_f32 v107, v24, v25
    v_cvt_pk_bf16_f32 v108, v26, v27
    v_cvt_pk_bf16_f32 v109, v28, v29
    v_cvt_pk_bf16_f32 v110, v30, v31
    v_cvt_pk_bf16_f32 v111, v32, v33
    s_nop 1
    v_permlane32_swap_b32 v104, v106
    v_permlane32_swap_b32 v105, v107
    v_permlane32_swap_b32 v108, v110
    v_permlane32_swap_b32 v109, v111
    buffer_store_dwordx4 v[104:107], v74, s[20:23], s42 offen
    buffer_store_dwordx4 v[108:111], v74, s[20:23], s42 offen offset:32
block_kernel_done:
block_kernel_end:
    s_endpgm
block_kernel_slow:
    s_lshl_b32 s42, s2, 16
    s_add_u32 s42, s42, 2097152
    v_mov_b32 v6, 0xff800000
    s_mov_b32 s45, 0
block_kernel_slow1:
    s_add_u32 s43, s42, s45
    buffer_load_dwordx4 v[136:139], v4, s[16:19], s43 offen
    s_waitcnt vmcnt(0)
    v_mfma_f32_32x32x16_bf16 v[24:39], v[136:139], v[10:13], 0
    s_nop 15
    v_max3_f32 v8, v24, v25, v26
    v_max3_f32 v8, v8, v27, v28
    v_max3_f32 v8, v8, v29, v30
    v_max3_f32 v8, v8, v31, v32
    v_max3_f32 v8, v8, v33, v34
    v_max3_f32 v8, v8, v35, v36
    v_max3_f32 v8, v8, v37, v38
    v_max_f32 v8, v8, v39
    v_max_f32 v6, v6, v8
    s_add_u32 s45, s45, 1024
    s_cmp_lt_u32 s45, 65536
    s_cbranch_scc1 block_kernel_slow1
    v_mov_b32 v7, v6
    s_nop 1
    v_permlane32_swap_b32 v6, v7
    s_nop 1
    v_max_f32 v6, v6, v7
    v_sub_f32 v56, 0, v6
    v_sub_f32 v57, 0, v6
    v_sub_f32 v58, 0, v6
    v_sub_f32 v59, 0, v6
    v_sub_f32 v60, 0, v6
    v_sub_f32 v61, 0, v6
    v_sub_f32 v62, 0, v6
    v_sub_f32 v63, 0, v6
    v_sub_f32 v64, 0, v6
    v_sub_f32 v65, 0, v6
    v_sub_f32 v66, 0, v6
    v_sub_f32 v67, 0, v6
    v_sub_f32 v68, 0, v6
    v_sub_f32 v69, 0, v6
    v_sub_f32 v70, 0, v6
    v_sub_f32 v71, 0, v6
    v_mov_b32 v88, 0
    v_mov_b32 v89, 0
    v_mov_b32 v90, 0
    v_mov_b32 v91, 0
    v_mov_b32 v92, 0
    v_mov_b32 v93, 0
    v_mov_b32 v94, 0
    v_mov_b32 v95, 0
    v_mov_b32 v96, 0
    v_mov_b32 v97, 0
    v_mov_b32 v98, 0
    v_mov_b32 v99, 0
    v_mov_b32 v100, 0
    v_mov_b32 v101, 0
    v_mov_b32 v102, 0
    v_mov_b32 v103, 0
    v_and_b32 v19, 15, v1
    v_lshlrev_b32 v19, 4, v19
    v_lshl_add_u32 v19, v3, 8, v19
    v_bfe_u32 v7, v1, 4, 1
    v_lshl_add_u32 v19, v7, 25, v19
    v_and_b32 v6, 27, v1
    v_cmp_eq_u32 vcc, 16, v6
    v_mov_b32 v7, 0x3f803f80
    s_mov_b32 s45, 0
    v_cndmask_b32 v18, 0, v7, vcc
block_kernel_slow2:
    s_add_u32 s43, s42, s45
    s_add_u32 s44, s43, 2097152
    buffer_load_dwordx4 v[136:139], v4, s[16:19], s43 offen
    buffer_load_dwordx4 v[140:143], v19, s[16:19], s44 offen
    buffer_load_dwordx4 v[144:147], v19, s[16:19], s44 offen offset:512
    s_waitcnt vmcnt(0)
    v_mfma_f32_32x32x16_bf16 v[24:39], v[136:139], v[10:13], v[56:71]
    v_or_b32 v140, v140, v18
    v_or_b32 v144, v144, v18
    v_or_b32 v141, v141, v18
    v_or_b32 v145, v145, v18
    v_or_b32 v142, v142, v18
    v_or_b32 v146, v146, v18
    v_or_b32 v143, v143, v18
    v_or_b32 v147, v147, v18
    s_nop 7
    v_exp_f32 v24, v24
    v_exp_f32 v25, v25
    v_exp_f32 v26, v26
    v_exp_f32 v27, v27
    v_exp_f32 v28, v28
    v_exp_f32 v29, v29
    v_exp_f32 v30, v30
    v_exp_f32 v31, v31
    v_exp_f32 v32, v32
    v_exp_f32 v33, v33
    v_exp_f32 v34, v34
    v_exp_f32 v35, v35
    v_exp_f32 v36, v36
    v_exp_f32 v37, v37
    v_exp_f32 v38, v38
    v_exp_f32 v39, v39
    s_nop 0
    v_cvt_pk_bf16_f32 v120, v24, v25
    v_cvt_pk_bf16_f32 v121, v26, v27
    v_cvt_pk_bf16_f32 v122, v28, v29
    v_cvt_pk_bf16_f32 v123, v30, v31
    v_cvt_pk_bf16_f32 v124, v32, v33
    v_cvt_pk_bf16_f32 v125, v34, v35
    v_cvt_pk_bf16_f32 v126, v36, v37
    v_cvt_pk_bf16_f32 v127, v38, v39
    s_nop 1
    v_mfma_f32_32x32x16_bf16 v[88:103], v[140:143], v[120:123], v[88:103]
    v_mfma_f32_32x32x16_bf16 v[88:103], v[144:147], v[124:127], v[88:103]
    s_add_u32 s45, s45, 1024
    s_cmp_lt_u32 s45, 65536
    s_cbranch_scc1 block_kernel_slow2
    s_nop 15
    s_branch block_kernel_fin
.section .rodata,"a"
.p2align 6
.amdhsa_kernel qkv_kernel
  .amdhsa_next_free_vgpr 226
  .amdhsa_next_free_sgpr 39
  .amdhsa_accum_offset 228
  .amdhsa_group_segment_fixed_size 0
  .amdhsa_kernarg_size 72
  .amdhsa_user_sgpr_count 2
  .amdhsa_user_sgpr_kernarg_segment_ptr 1
  .amdhsa_system_sgpr_workgroup_id_x 1
.end_amdhsa_kernel
.p2align 6
.amdhsa_kernel block_kernel
  .amdhsa_next_free_vgpr 256
  .amdhsa_next_free_sgpr 50
  .amdhsa_accum_offset 152
  .amdhsa_group_segment_fixed_size 0
  .amdhsa_kernarg_size 72
  .amdhsa_user_sgpr_count 2
  .amdhsa_user_sgpr_kernarg_segment_ptr 1
  .amdhsa_system_sgpr_workgroup_id_x 1
.end_amdhsa_kernel
```
